```python
import torch

def _softmax(x, axis=-1):
    return torch.softmax(x, dim=axis)
def _gelu(x):
    return torch.nn.functional.gelu(x, approximate="tanh")
def _silu(x):
    return torch.nn.functional.silu(x)
def _sigmoid(x):
    return torch.sigmoid(x)
def _layernorm(x, axis=-1, eps=1e-5):
    m = x.mean(dim=axis, keepdim=True)
    v = x.var(dim=axis, keepdim=True, unbiased=False)
    return (x - m) / torch.sqrt(v + eps)
def _scatter_add(tgt, idx, src, axis=0):
    return tgt.clone().index_add_(axis, idx, src)
def _segment_sum(src, seg, n):
    out = torch.zeros((n,) + src.shape[1:], dtype=src.dtype)
    return out.index_add_(0, seg, src)
def _pad(x, pw):
    flat = tuple(v for pair in reversed(pw) for v in pair)
    return torch.nn.functional.pad(x, flat)

kernel_name = 'interleave_layers__softmax_full_mha__dense_activation_mish__prompt'

def setup_inputs():

    _w = (lambda a: (lambda t: t.to(torch.bfloat16) if t.is_floating_point() else t)(torch.as_tensor(a)))
    def _A_setup():
        B, S, D = 1, 2048, 448
        return {
            "x": _w((lambda *s: torch.randn(*s, dtype=torch.bfloat16) * 0.05)(B, S, D)),
            "wqkv": _w((lambda *s: torch.randn(*s, dtype=torch.bfloat16) * 0.05)(D, 3 * D)),
            "wo": _w((lambda *s: torch.randn(*s, dtype=torch.bfloat16) * 0.05)(D, D)),
        }
    _A_in = _A_setup()

    def _B_setup():
        B, S, D, F = 1, 2048, 448, 1792
        return {
            "x": _w((lambda *s: torch.randn(*s, dtype=torch.bfloat16) * 0.05)(B, S, D)),
            "w1": _w((lambda *s: torch.randn(*s, dtype=torch.bfloat16) * 1.6)(D, F) * (D ** -0.5)),
            "b1": _w((lambda *s: torch.randn(*s, dtype=torch.bfloat16) * 0.2)(F)),
            "w2": _w((lambda *s: torch.randn(*s, dtype=torch.bfloat16) * 0.2)(F, D) * (F ** -0.5)),
        }
    _B_in = _B_setup()

    return {
        "A_x": _A_in["x"],
        "A_wqkv": _A_in["wqkv"],
        "A_wo": _A_in["wo"],
        "B_x": _B_in["x"],
        "B_w1": _B_in["w1"],
        "B_b1": _B_in["b1"],
        "B_w2": _B_in["w2"],
    }

def reference(A_x, A_wqkv, A_wo, B_x, B_w1, B_b1, B_w2):
    def _A_ref(x, wqkv, wo):
        B, S, D = x.shape
        H = 16; Dh = D // H
        qkv = (lambda x, *d: x.permute(*d))((x @ wqkv).reshape(B, S, 3, H, Dh), 2, 0, 3, 1, 4)
        q, k, v = qkv[0], qkv[1], qkv[2]
        scale = Dh ** -0.5
        scores = torch.einsum("bhqd,bhkd->bhqk", q, k) * scale
        p = _softmax(scores, axis=-1)
        o = torch.einsum("bhqk,bhkd->bhqd", p, v)
        return (lambda x, *d: x.permute(*d))(o, 0, 2, 1, 3).reshape(B, S, D) @ wo

    def _B_ref(x, w1, b1, w2):
        h = torch.einsum("bsd,df->bsf", x, w1) + b1
        sp = torch.log1p(torch.exp(-torch.abs(h))) + torch.where(h > 0, h, torch.zeros_like(h))
        act = h * torch.tanh(sp)
        return torch.einsum("bsf,fd->bsd", act, w2)

    x = A_x
    x = x + _A_ref(_layernorm(x, axis=-1), A_wqkv, A_wo)
    x = x + _B_ref(_layernorm(x, axis=-1), B_w1, B_b1, B_w2)
    x = x + _A_ref(_layernorm(x, axis=-1), A_wqkv, A_wo)
    x = x + _B_ref(_layernorm(x, axis=-1), B_w1, B_b1, B_w2)
    return x
```

```asm
; @launch grid=(256,1,1) block=(256,1,1) lds=145408
.amdgcn_target "amdgcn-amd-amdhsa--gfx950"
.text
.globl interleave_layers__softmax_full_mha__dense_activation_mish__prompt_kernel
.p2align 8
.type interleave_layers__softmax_full_mha__dense_activation_mish__prompt_kernel,@function
interleave_layers__softmax_full_mha__dense_activation_mish__prompt_kernel:
  s_cmp_ge_u32 s2, 256
  s_cbranch_scc1 L_end
  s_load_dwordx2 s[12:13], s[0:1], 8
  s_mov_b32 s14, 0x00126000
  s_mov_b32 s15, 0x00020000
  s_load_dwordx2 s[24:25], s[0:1], 0
  s_mov_b32 s26, 0x001c0000
  s_mov_b32 s27, 0x00020000
  s_load_dwordx2 s[8:9], s[0:1], 72
  s_mov_b32 s10, 0x10000000
  s_mov_b32 s11, 0x00020000
  s_load_dwordx2 s[16:17], s[0:1], 64
  s_mov_b32 s18, 0x00000100
  s_mov_b32 s19, 0x00020000
  s_load_dwordx2 s[20:21], s[0:1], 56
  s_mov_b32 s22, 0x001c0000
  s_mov_b32 s23, 0x00020000
  v_and_b32 v2, 63, v0
  v_lshrrev_b32 v4, 6, v0
  v_lshlrev_b32 v1, 4, v2
  v_readfirstlane_b32 s3, v4
  v_add_u32 v5, 0x10000, v1
  v_add_u32 v6, 0x20000, v1
  v_mov_b32 v3, 1
  s_and_b32 s4, s2, 7
  s_lshr_b32 s5, s2, 3
  s_mov_b32 s60, 0
  s_mov_b32 s62, 0
  s_mov_b32 s63, -1
  s_mov_b32 s64, -1
  s_mov_b32 s65, 0
  s_mov_b32 s66, 0x10000000
  s_mov_b32 s67, 0x10000000
  s_mov_b32 s72, 0x0fffffff
  s_mov_b32 s73, 0x0fffffff
  s_mov_b32 s74, 0xf000f000
  s_mov_b32 s75, 0xf000f000
  s_mov_b32 s100, -1
  s_mov_b32 s101, 0x00ffffff
  s_lshr_b32 s30, s5, 4
  s_lshl_b32 s31, s4, 1
  s_add_u32 s76, s30, s31
  s_and_b32 s77, s5, 15
  s_mov_b32 s78, s76
  s_mov_b32 s79, s77
  s_mul_i32 s30, s5, 37
  s_lshr_b32 s30, s30, 8
  s_mul_i32 s31, s30, 7
  s_sub_u32 s81, s5, s31
  s_lshl_b32 s32, s4, 2
  s_add_u32 s80, s30, s32
  s_cmp_ge_u32 s5, 14
  s_cselect_b32 s30, 1, 0
  s_mul_i32 s31, s30, 14
  s_sub_u32 s83, s5, s31
  s_lshl_b32 s32, s4, 1
  s_add_u32 s82, s30, s32
  s_mov_b32 s6, 0
  s_mov_b32 s84, 0
  s_getreg_b32 s59, hwreg(HW_REG_XCC_ID)
  s_add_u32 s59, s59, 1
  v_lshrrev_b32 v16, 5, v2
  v_bfe_u32 v17, v2, 2, 3
  v_and_b32 v18, 3, v2
  v_and_b32 v19, 3, v17
  v_lshlrev_b32 v19, 4, v19
  v_lshl_add_u32 v19, v16, 3, v19
  v_mul_u32_u24 v20, 2688, v19
  v_lshl_add_u32 v20, v18, 4, v20
  v_lshrrev_b32 v19, 2, v17
  v_mul_u32_u24 v19, 56, v19
  v_add_u32 v20, v20, v19
  v_cmp_eq_u32 vcc, 3, v18
  v_subrev_u32 v21, 8, v20
  s_nop 0
  v_cndmask_b32 v20, v20, v21, vcc
  s_sub_u32 s56, s2, 1
  s_lshl_b32 s55, s56, 2
  s_add_u32 s55, s55, s3
  s_mul_i32 s33, s55, 9363
  s_lshr_b32 s33, s33, 16
  s_mul_i32 s34, s33, 7
  s_sub_u32 s52, s55, s34
  s_mul_i32 s54, s33, 21846
  s_lshr_b32 s54, s54, 16
  s_mul_i32 s34, s54, 3
  s_sub_u32 s53, s33, s34
  s_mul_i32 s33, s52, 172032
  s_mul_i32 s34, s53, 896
  s_add_u32 s33, s33, s34
  s_mul_i32 s34, s54, 112
  s_add_u32 s33, s33, s34
  s_waitcnt lgkmcnt(0)
  s_cmp_lg_u32 s2, 0
  s_cbranch_scc1 L_noz_2
  s_cmp_lg_u32 s3, 3
  s_cbranch_scc1 L_noz_2
  v_mov_b32 v24, 0
  v_mov_b32 v25, 0
  v_mov_b32 v26, 0
  v_mov_b32 v27, 0
  s_mov_b32 s34, 0
  buffer_store_dwordx4 v[24:27], v1, s[8:11], s34 offen sc1
  s_mov_b32 s34, 1024
  buffer_store_dwordx4 v[24:27], v1, s[8:11], s34 offen sc1
  s_mov_b32 s34, 2048
  buffer_store_dwordx4 v[24:27], v1, s[8:11], s34 offen sc1
  s_mov_b32 s34, 3072
  buffer_store_dwordx4 v[24:27], v1, s[8:11], s34 offen sc1
  s_mov_b32 s34, 4096
  buffer_store_dwordx4 v[24:27], v1, s[8:11], s34 offen sc1
  s_mov_b32 s34, 5120
  buffer_store_dwordx4 v[24:27], v1, s[8:11], s34 offen sc1
  s_mov_b32 s34, 6144
  buffer_store_dwordx4 v[24:27], v1, s[8:11], s34 offen sc1
  s_mov_b32 s34, 7168
  buffer_store_dwordx4 v[24:27], v1, s[8:11], s34 offen sc1
  s_mov_b32 s34, 8192
  buffer_store_dwordx4 v[24:27], v1, s[8:11], s34 offen sc1
  s_mov_b32 s34, 9216
  buffer_store_dwordx4 v[24:27], v1, s[8:11], s34 offen sc1
  s_mov_b32 s34, 10240
  buffer_store_dwordx4 v[24:27], v1, s[8:11], s34 offen sc1
  s_mov_b32 s34, 11264
  buffer_store_dwordx4 v[24:27], v1, s[8:11], s34 offen sc1
  s_mov_b32 s34, 12288
  buffer_store_dwordx4 v[24:27], v1, s[8:11], s34 offen sc1
  s_mov_b32 s34, 13312
  buffer_store_dwordx4 v[24:27], v1, s[8:11], s34 offen sc1
  s_mov_b32 s34, 14336
  buffer_store_dwordx4 v[24:27], v1, s[8:11], s34 offen sc1
  s_mov_b32 s34, 15360
  buffer_store_dwordx4 v[24:27], v1, s[8:11], s34 offen sc1
  s_mov_b32 s34, 16384
  buffer_store_dwordx4 v[24:27], v1, s[8:11], s34 offen sc1
  s_mov_b32 s34, 17408
  buffer_store_dwordx4 v[24:27], v1, s[8:11], s34 offen sc1
  s_mov_b32 s34, 18432
  buffer_store_dwordx4 v[24:27], v1, s[8:11], s34 offen sc1
  s_mov_b32 s34, 19456
  buffer_store_dwordx4 v[24:27], v1, s[8:11], s34 offen sc1
  s_mov_b32 s34, 20480
  buffer_store_dwordx4 v[24:27], v1, s[8:11], s34 offen sc1
  s_mov_b32 s34, 21504
  buffer_store_dwordx4 v[24:27], v1, s[8:11], s34 offen sc1
  s_mov_b32 s34, 22528
  buffer_store_dwordx4 v[24:27], v1, s[8:11], s34 offen sc1
  s_mov_b32 s34, 23552
  buffer_store_dwordx4 v[24:27], v1, s[8:11], s34 offen sc1
  s_waitcnt vmcnt(0)
  buffer_store_dword v3, off, s[16:19], 0 sc1
L_noz_2:
  v_mul_u32_u24 v21, 4682, v2
  v_lshrrev_b32 v21, 16, v21
  v_mul_u32_u24 v28, 14, v21
  v_sub_u32 v28, v2, v28
  v_mul_u32_u24 v29, 896, v21
  v_lshl_add_u32 v29, v28, 4, v29
  s_mul_i32 s34, s3, 7680
  v_lshrrev_b32 v30, 1, v28
  v_mul_u32_u24 v30, 1088, v30
  v_and_b32 v28, 1, v28
  v_mul_u32_u24 v28, 544, v28
  v_add_u32 v30, v30, v28
  v_lshl_add_u32 v30, v21, 4, v30
  v_add_u32 v30, s34, v30
  v_and_b32 v31, 31, v2
  v_lshlrev_b32 v31, 4, v31
  v_mul_u32_u24 v28, 544, v16
  v_add_u32 v31, v31, v28
  v_add_u32 v31, s34, v31
  s_lshl_b32 s36, s76, 2
  s_add_u32 s36, s36, s3
  s_mul_i32 s36, s36, 28672
  s_cmp_ge_u32 s56, 42
  s_cbranch_scc1 L_nou2_3
  buffer_load_dwordx4 v[48:51], v20, s[12:15], s33 offen
  s_add_u32 s33, s33, 2688
  buffer_load_dwordx4 v[52:55], v20, s[12:15], s33 offen
  s_add_u32 s33, s33, 2688
  buffer_load_dwordx4 v[56:59], v20, s[12:15], s33 offen
  s_add_u32 s33, s33, 2688
  buffer_load_dwordx4 v[60:63], v20, s[12:15], s33 offen
  s_add_u32 s33, s33, 2688
  buffer_load_dwordx4 v[64:67], v20, s[12:15], s33 offen
  s_add_u32 s33, s33, 2688
  buffer_load_dwordx4 v[68:71], v20, s[12:15], s33 offen
  s_add_u32 s33, s33, 2688
  buffer_load_dwordx4 v[72:75], v20, s[12:15], s33 offen
  s_add_u32 s33, s33, 2688
  buffer_load_dwordx4 v[76:79], v20, s[12:15], s33 offen
  s_mov_b32 s30, 0x05040100
  s_mov_b32 s31, 0x07060302
  s_mov_b32 s32, 0x3f803f80
  s_mul_i32 s37, s3, 8448
  s_add_u32 s37, s37, 53248
  v_mul_u32_u24 v24, 1040, v17
  v_lshl_add_u32 v24, v16, 9, v24
  v_lshrrev_b32 v19, 1, v18
  v_lshl_add_u32 v24, v19, 8, v24
  v_and_b32 v19, 1, v18
  v_lshl_add_u32 v24, v19, 6, v24
  v_add_u32 v24, s37, v24
  v_add_u32 v25, 0x80, v24
  v_cmp_eq_u32 vcc, 3, v18
  v_mov_b32 v19, v24
  s_nop 0
  v_cndmask_b32 v24, v24, v25, vcc
  v_cndmask_b32 v25, v25, v19, vcc
  s_lshl_b32 s35, s3, 9
  s_add_u32 s35, s35, 40960
  v_lshrrev_b32 v19, 4, v2
  v_lshlrev_b32 v26, 7, v19
  v_lshl_add_u32 v26, v18, 5, v26
  v_add_u32 v26, s35, v26
  v_add_u32 v27, 16, v26
  v_cmp_eq_u32 vcc, 3, v18
  v_mov_b32 v19, v26
  s_nop 0
  v_cndmask_b32 v26, v26, v27, vcc
  v_cndmask_b32 v27, v27, v19, vcc
  v_mov_b32 v16, 0
  v_mov_b32 v17, 0
  v_mov_b32 v18, 0
  v_mov_b32 v19, 0
  v_mov_b32 v20, 0
  v_mov_b32 v21, 0
  v_mov_b32 v22, 0
  v_mov_b32 v23, 0
  s_waitcnt vmcnt(6)
  v_perm_b32 v32, v52, v48, s30
  s_waitcnt vmcnt(4)
  v_perm_b32 v33, v60, v56, s30
  s_waitcnt vmcnt(2)
  v_perm_b32 v34, v68, v64, s30
  s_waitcnt vmcnt(0)
  v_perm_b32 v35, v76, v72, s30
  v_perm_b32 v36, v52, v48, s31
  v_perm_b32 v37, v60, v56, s31
  v_perm_b32 v38, v68, v64, s31
  v_perm_b32 v39, v76, v72, s31
  v_perm_b32 v40, v53, v49, s30
  v_perm_b32 v41, v61, v57, s30
  v_perm_b32 v42, v69, v65, s30
  v_perm_b32 v43, v77, v73, s30
  v_perm_b32 v44, v53, v49, s31
  v_perm_b32 v45, v61, v57, s31
  v_perm_b32 v46, v69, v65, s31
  v_perm_b32 v47, v77, v73, s31
  ds_write_b128 v24, v[32:35] offset:0
  ds_write_b128 v24, v[36:39] offset:16
  ds_write_b128 v24, v[40:43] offset:32
  ds_write_b128 v24, v[44:47] offset:48
  v_dot2_f32_bf16 v16, v32, s32, v16
  v_dot2_f32_bf16 v17, v36, s32, v17
  v_dot2_f32_bf16 v18, v40, s32, v18
  v_dot2_f32_bf16 v19, v44, s32, v19
  v_dot2_f32_bf16 v16, v33, s32, v16
  v_dot2_f32_bf16 v17, v37, s32, v17
  v_dot2_f32_bf16 v18, v41, s32, v18
  v_dot2_f32_bf16 v19, v45, s32, v19
  v_dot2_f32_bf16 v16, v34, s32, v16
  v_dot2_f32_bf16 v17, v38, s32, v17
  v_dot2_f32_bf16 v18, v42, s32, v18
  v_dot2_f32_bf16 v19, v46, s32, v19
  v_dot2_f32_bf16 v16, v35, s32, v16
  v_dot2_f32_bf16 v17, v39, s32, v17
  v_dot2_f32_bf16 v18, v43, s32, v18
  v_dot2_f32_bf16 v19, v47, s32, v19
  v_perm_b32 v32, v54, v50, s30
  v_perm_b32 v33, v62, v58, s30
  v_perm_b32 v34, v70, v66, s30
  v_perm_b32 v35, v78, v74, s30
  v_perm_b32 v36, v54, v50, s31
  v_perm_b32 v37, v62, v58, s31
  v_perm_b32 v38, v70, v66, s31
  v_perm_b32 v39, v78, v74, s31
  v_perm_b32 v40, v55, v51, s30
  v_perm_b32 v41, v63, v59, s30
  v_perm_b32 v42, v71, v67, s30
  v_perm_b32 v43, v79, v75, s30
  v_perm_b32 v44, v55, v51, s31
  v_perm_b32 v45, v63, v59, s31
  v_perm_b32 v46, v71, v67, s31
  v_perm_b32 v47, v79, v75, s31
  ds_write_b128 v25, v[32:35] offset:0
  ds_write_b128 v25, v[36:39] offset:16
  ds_write_b128 v25, v[40:43] offset:32
  ds_write_b128 v25, v[44:47] offset:48
  v_dot2_f32_bf16 v20, v32, s32, v20
  v_dot2_f32_bf16 v21, v36, s32, v21
  v_dot2_f32_bf16 v22, v40, s32, v22
  v_dot2_f32_bf16 v23, v44, s32, v23
  v_dot2_f32_bf16 v20, v33, s32, v20
  v_dot2_f32_bf16 v21, v37, s32, v21
  v_dot2_f32_bf16 v22, v41, s32, v22
  v_dot2_f32_bf16 v23, v45, s32, v23
  v_dot2_f32_bf16 v20, v34, s32, v20
  v_dot2_f32_bf16 v21, v38, s32, v21
  v_dot2_f32_bf16 v22, v42, s32, v22
  v_dot2_f32_bf16 v23, v46, s32, v23
  v_dot2_f32_bf16 v20, v35, s32, v20
  v_dot2_f32_bf16 v21, v39, s32, v21
  v_dot2_f32_bf16 v22, v43, s32, v22
  v_dot2_f32_bf16 v23, v47, s32, v23
  v_add_f32_dpp v16, v16, v16 row_shr:4 row_mask:0xf bank_mask:0xf bound_ctrl:0
  v_add_f32_dpp v17, v17, v17 row_shr:4 row_mask:0xf bank_mask:0xf bound_ctrl:0
  v_add_f32_dpp v18, v18, v18 row_shr:4 row_mask:0xf bank_mask:0xf bound_ctrl:0
  v_add_f32_dpp v19, v19, v19 row_shr:4 row_mask:0xf bank_mask:0xf bound_ctrl:0
  v_add_f32_dpp v20, v20, v20 row_shr:4 row_mask:0xf bank_mask:0xf bound_ctrl:0
  v_add_f32_dpp v21, v21, v21 row_shr:4 row_mask:0xf bank_mask:0xf bound_ctrl:0
  v_add_f32_dpp v22, v22, v22 row_shr:4 row_mask:0xf bank_mask:0xf bound_ctrl:0
  v_add_f32_dpp v23, v23, v23 row_shr:4 row_mask:0xf bank_mask:0xf bound_ctrl:0
  v_add_f32_dpp v16, v16, v16 row_shr:8 row_mask:0xf bank_mask:0xf bound_ctrl:0
  v_add_f32_dpp v17, v17, v17 row_shr:8 row_mask:0xf bank_mask:0xf bound_ctrl:0
  v_add_f32_dpp v18, v18, v18 row_shr:8 row_mask:0xf bank_mask:0xf bound_ctrl:0
  v_add_f32_dpp v19, v19, v19 row_shr:8 row_mask:0xf bank_mask:0xf bound_ctrl:0
  v_add_f32_dpp v20, v20, v20 row_shr:8 row_mask:0xf bank_mask:0xf bound_ctrl:0
  v_add_f32_dpp v21, v21, v21 row_shr:8 row_mask:0xf bank_mask:0xf bound_ctrl:0
  v_add_f32_dpp v22, v22, v22 row_shr:8 row_mask:0xf bank_mask:0xf bound_ctrl:0
  v_add_f32_dpp v23, v23, v23 row_shr:8 row_mask:0xf bank_mask:0xf bound_ctrl:0
  s_mov_b64 exec, s[74:75]
  ds_write_b128 v26, v[16:19] offset:0
  ds_write_b128 v27, v[20:23] offset:0
  s_mov_b64 exec, -1
  v_add_u32 v22, s37, v1
  s_lshl_b32 s35, s3, 9
  s_add_u32 s35, s35, 40960
  v_add_u32 v23, s35, v1
  ds_read_b128 v[80:83], v22 offset:0
  ds_read_b128 v[84:87], v22 offset:1040
  ds_read_b128 v[88:91], v22 offset:2080
  ds_read_b128 v[92:95], v22 offset:3120
  ds_read_b128 v[96:99], v22 offset:4160
  ds_read_b128 v[100:103], v22 offset:5200
  ds_read_b128 v[104:107], v22 offset:6240
  ds_read_b128 v[108:111], v22 offset:7280
  ds_read_b128 v[112:115], v23
  s_mul_i32 s33, s54, 174
  s_mul_i32 s34, s53, 29
  s_add_u32 s33, s33, s34
  s_lshl_b32 s34, s52, 2
  s_add_u32 s33, s33, s34
  s_lshl_b32 s33, s33, 10
  s_add_u32 s33, s33, 65536
  s_add_u32 s34, s33, 89088
  s_waitcnt lgkmcnt(8)
  buffer_store_dwordx4 v[80:83], v1, s[8:11], s33 offen offset:0 sc1
  s_waitcnt lgkmcnt(7)
  buffer_store_dwordx4 v[84:87], v1, s[8:11], s33 offen offset:1024 sc1
  s_waitcnt lgkmcnt(6)
  buffer_store_dwordx4 v[88:91], v1, s[8:11], s33 offen offset:2048 sc1
  s_waitcnt lgkmcnt(5)
  buffer_store_dwordx4 v[92:95], v1, s[8:11], s33 offen offset:3072 sc1
  s_waitcnt lgkmcnt(4)
  buffer_store_dwordx4 v[96:99], v1, s[8:11], s34 offen offset:0 sc1
  s_waitcnt lgkmcnt(3)
  buffer_store_dwordx4 v[100:103], v1, s[8:11], s34 offen offset:1024 sc1
  s_waitcnt lgkmcnt(2)
  buffer_store_dwordx4 v[104:107], v1, s[8:11], s34 offen offset:2048 sc1
  s_waitcnt lgkmcnt(1)
  buffer_store_dwordx4 v[108:111], v1, s[8:11], s34 offen offset:3072 sc1
  s_lshl_b32 s35, s55, 9
  s_add_u32 s35, s35, 45064192
  s_mov_b64 exec, s[64:65]
  s_waitcnt lgkmcnt(0)
  buffer_store_dwordx4 v[112:115], v1, s[8:11], s35 offen sc1
  s_mov_b64 exec, -1
  buffer_load_dword v119, off, s[16:19], 0 sc1
L_nou2_3:
  s_mov_b64 exec, s[100:101]
  s_add_u32 s34, s36, 0
  buffer_load_dwordx4 a[64:67], v29, s[24:27], s34 offen offset:0
  s_add_u32 s34, s36, 3584
  buffer_load_dwordx4 a[68:71], v29, s[24:27], s34 offen offset:0
  s_add_u32 s34, s36, 7168
  buffer_load_dwordx4 a[72:75], v29, s[24:27], s34 offen offset:0
  s_add_u32 s34, s36, 10752
  buffer_load_dwordx4 a[76:79], v29, s[24:27], s34 offen offset:0
  s_add_u32 s34, s36, 14336
  buffer_load_dwordx4 a[80:83], v29, s[24:27], s34 offen offset:0
  s_add_u32 s34, s36, 17920
  buffer_load_dwordx4 a[84:87], v29, s[24:27], s34 offen offset:0
  s_add_u32 s34, s36, 21504
  buffer_load_dwordx4 a[88:91], v29, s[24:27], s34 offen offset:0
  s_add_u32 s34, s36, 25088
  buffer_load_dwordx4 a[92:95], v29, s[24:27], s34 offen offset:0
  s_add_u32 s34, s36, 0
  buffer_load_dwordx4 a[96:99], v29, s[24:27], s34 offen offset:224
  s_add_u32 s34, s36, 3584
  buffer_load_dwordx4 a[100:103], v29, s[24:27], s34 offen offset:224
  s_add_u32 s34, s36, 7168
  buffer_load_dwordx4 a[104:107], v29, s[24:27], s34 offen offset:224
  s_add_u32 s34, s36, 10752
  buffer_load_dwordx4 a[108:111], v29, s[24:27], s34 offen offset:224
  s_add_u32 s34, s36, 14336
  buffer_load_dwordx4 a[112:115], v29, s[24:27], s34 offen offset:224
  s_add_u32 s34, s36, 17920
  buffer_load_dwordx4 a[116:119], v29, s[24:27], s34 offen offset:224
  s_add_u32 s34, s36, 21504
  buffer_load_dwordx4 a[120:123], v29, s[24:27], s34 offen offset:224
  s_add_u32 s34, s36, 25088
  buffer_load_dwordx4 a[124:127], v29, s[24:27], s34 offen offset:224
  s_mov_b64 exec, -1
  s_cmp_ge_u32 s56, 42
  s_cbranch_scc1 L_nou3_4
  s_waitcnt vmcnt(16)
  v_cmp_eq_u32 vcc, 1, v119
  s_nop 0
  s_cmp_eq_u64 vcc, -1
  s_cbranch_scc1 L_g3_5
  s_cmp_lg_u32 s60, 0
  s_cbranch_scc1 L_wd_6
  v_lshlrev_b32 v4, 2, v2
  v_add_u32 v4, 0, v4
  s_mov_b32 exec_lo, 0x00000001
  s_mov_b32 exec_hi, 0x00000000
  s_mov_b32 s58, 0
L_poll_7:
  buffer_load_dword v7, v4, s[16:19], 0 offen sc1
  s_waitcnt vmcnt(0)
  v_cmp_eq_u32 vcc, 1, v7
  s_add_u32 s58, s58, 1
  s_cmp_eq_u64 vcc, exec
  s_cbranch_scc1 L_wd_6_d
  s_cmp_lt_u32 s58, 60000
  s_cbranch_scc1 L_poll_7
  s_or_b32 s60, s60, 1
L_wd_6_d:
  s_mov_b64 exec, -1
L_wd_6:
L_g3_5:
  s_mul_i32 s34, s54, 3
  s_add_u32 s34, s34, s53
  s_lshl_b32 s34, s34, 7
  s_lshl_b32 s35, s52, 2
  s_add_u32 s34, s34, s35
  s_add_u32 s34, s34, 21504
  v_mov_b32 v4, s34
  s_mov_b64 exec, 1
  buffer_store_dword v3, v4, s[8:11], 0 offen sc1
  s_mov_b64 exec, -1
L_nou3_4:
  s_mov_b64 exec, s[100:101]
  s_add_u32 s34, s36, 0
  buffer_load_dwordx4 a[128:131], v29, s[24:27], s34 offen offset:448
  s_add_u32 s34, s36, 3584
  buffer_load_dwordx4 a[132:135], v29, s[24:27], s34 offen offset:448
  s_add_u32 s34, s36, 7168
  buffer_load_dwordx4 a[136:139], v29, s[24:27], s34 offen offset:448
  s_add_u32 s34, s36, 10752
  buffer_load_dwordx4 a[140:143], v29, s[24:27], s34 offen offset:448
  s_add_u32 s34, s36, 14336
  buffer_load_dwordx4 a[144:147], v29, s[24:27], s34 offen offset:448
  s_add_u32 s34, s36, 17920
  buffer_load_dwordx4 a[148:151], v29, s[24:27], s34 offen offset:448
  s_add_u32 s34, s36, 21504
  buffer_load_dwordx4 a[152:155], v29, s[24:27], s34 offen offset:448
  s_add_u32 s34, s36, 25088
  buffer_load_dwordx4 a[156:159], v29, s[24:27], s34 offen offset:448
  s_add_u32 s34, s36, 0
  buffer_load_dwordx4 a[160:163], v29, s[24:27], s34 offen offset:672
  s_add_u32 s34, s36, 3584
  buffer_load_dwordx4 a[164:167], v29, s[24:27], s34 offen offset:672
  s_add_u32 s34, s36, 7168
  buffer_load_dwordx4 a[168:171], v29, s[24:27], s34 offen offset:672
  s_add_u32 s34, s36, 10752
  buffer_load_dwordx4 a[172:175], v29, s[24:27], s34 offen offset:672
  s_add_u32 s34, s36, 14336
  buffer_load_dwordx4 a[176:179], v29, s[24:27], s34 offen offset:672
  s_add_u32 s34, s36, 17920
  buffer_load_dwordx4 a[180:183], v29, s[24:27], s34 offen offset:672
  s_add_u32 s34, s36, 21504
  buffer_load_dwordx4 a[184:187], v29, s[24:27], s34 offen offset:672
  s_add_u32 s34, s36, 25088
  buffer_load_dwordx4 a[188:191], v29, s[24:27], s34 offen offset:672
  s_mov_b64 exec, -1
  buffer_load_dword v116, off, s[16:19], 0 sc1
  s_mov_b32 s30, 0x05040100
  s_mov_b32 s31, 0x07060302
  s_mov_b32 s32, 0x3f803f80
  v_mov_b32 v88, 0
  v_mov_b32 v89, 0
  v_mov_b32 v102, 0
  v_mov_b32 v103, 0
  s_mov_b64 exec, s[100:101]
  s_waitcnt vmcnt(32)
  ds_write_b128 v30, a[64:67] offset:0
  s_waitcnt vmcnt(31)
  ds_write_b128 v30, a[68:71] offset:64
  s_waitcnt vmcnt(30)
  ds_write_b128 v30, a[72:75] offset:128
  s_waitcnt vmcnt(29)
  ds_write_b128 v30, a[76:79] offset:192
  s_waitcnt vmcnt(28)
  ds_write_b128 v30, a[80:83] offset:256
  s_waitcnt vmcnt(27)
  ds_write_b128 v30, a[84:87] offset:320
  s_waitcnt vmcnt(26)
  ds_write_b128 v30, a[88:91] offset:384
  s_waitcnt vmcnt(25)
  ds_write_b128 v30, a[92:95] offset:448
  s_mov_b64 exec, -1
  ds_read_b128 v[144:147], v31 offset:0
  ds_read_b128 v[148:151], v31 offset:1088
  ds_read_b128 v[152:155], v31 offset:2176
  ds_read_b128 v[156:159], v31 offset:3264
  ds_read_b128 v[160:163], v31 offset:4352
  ds_read_b128 v[164:167], v31 offset:5440
  ds_read_b128 v[168:171], v31 offset:6528
  s_mov_b64 exec, s[100:101]
  s_waitcnt vmcnt(24)
  ds_write_b128 v30, a[96:99] offset:0
  s_waitcnt vmcnt(23)
  ds_write_b128 v30, a[100:103] offset:64
  s_waitcnt vmcnt(22)
  ds_write_b128 v30, a[104:107] offset:128
  s_waitcnt vmcnt(21)
  ds_write_b128 v30, a[108:111] offset:192
  s_waitcnt vmcnt(20)
  ds_write_b128 v30, a[112:115] offset:256
  s_waitcnt vmcnt(19)
  ds_write_b128 v30, a[116:119] offset:320
  s_waitcnt vmcnt(18)
  ds_write_b128 v30, a[120:123] offset:384
  s_waitcnt vmcnt(17)
  ds_write_b128 v30, a[124:127] offset:448
  s_mov_b64 exec, -1
  ds_read_b128 v[172:175], v31 offset:0
  ds_read_b128 v[176:179], v31 offset:1088
  ds_read_b128 v[180:183], v31 offset:2176
  ds_read_b128 v[184:187], v31 offset:3264
  ds_read_b128 v[188:191], v31 offset:4352
  ds_read_b128 v[192:195], v31 offset:5440
  ds_read_b128 v[196:199], v31 offset:6528
  s_waitcnt lgkmcnt(15)
  v_dot2_f32_bf16 v88, v144, s32, v88
  v_dot2_f32_bf16 v89, v144, v144, v89
  v_dot2_f32_bf16 v102, v145, s32, v102
  v_dot2_f32_bf16 v103, v145, v145, v103
  v_dot2_f32_bf16 v88, v146, s32, v88
  v_dot2_f32_bf16 v89, v146, v146, v89
  v_dot2_f32_bf16 v102, v147, s32, v102
  v_dot2_f32_bf16 v103, v147, v147, v103
  v_dot2_f32_bf16 v88, v148, s32, v88
  v_dot2_f32_bf16 v89, v148, v148, v89
  v_dot2_f32_bf16 v102, v149, s32, v102
  v_dot2_f32_bf16 v103, v149, v149, v103
  v_dot2_f32_bf16 v88, v150, s32, v88
  v_dot2_f32_bf16 v89, v150, v150, v89
  v_dot2_f32_bf16 v102, v151, s32, v102
  v_dot2_f32_bf16 v103, v151, v151, v103
  v_dot2_f32_bf16 v88, v152, s32, v88
  v_dot2_f32_bf16 v89, v152, v152, v89
  v_dot2_f32_bf16 v102, v153, s32, v102
  v_dot2_f32_bf16 v103, v153, v153, v103
  v_dot2_f32_bf16 v88, v154, s32, v88
  v_dot2_f32_bf16 v89, v154, v154, v89
  v_dot2_f32_bf16 v102, v155, s32, v102
  v_dot2_f32_bf16 v103, v155, v155, v103
  v_dot2_f32_bf16 v88, v156, s32, v88
  v_dot2_f32_bf16 v89, v156, v156, v89
  v_dot2_f32_bf16 v102, v157, s32, v102
  v_dot2_f32_bf16 v103, v157, v157, v103
  v_dot2_f32_bf16 v88, v158, s32, v88
  v_dot2_f32_bf16 v89, v158, v158, v89
  v_dot2_f32_bf16 v102, v159, s32, v102
  v_dot2_f32_bf16 v103, v159, v159, v103
  v_dot2_f32_bf16 v88, v160, s32, v88
  v_dot2_f32_bf16 v89, v160, v160, v89
  v_dot2_f32_bf16 v102, v161, s32, v102
  v_dot2_f32_bf16 v103, v161, v161, v103
  v_dot2_f32_bf16 v88, v162, s32, v88
  v_dot2_f32_bf16 v89, v162, v162, v89
  v_dot2_f32_bf16 v102, v163, s32, v102
  v_dot2_f32_bf16 v103, v163, v163, v103
  v_dot2_f32_bf16 v88, v164, s32, v88
  v_dot2_f32_bf16 v89, v164, v164, v89
  v_dot2_f32_bf16 v102, v165, s32, v102
  v_dot2_f32_bf16 v103, v165, v165, v103
  v_dot2_f32_bf16 v88, v166, s32, v88
  v_dot2_f32_bf16 v89, v166, v166, v89
  v_dot2_f32_bf16 v102, v167, s32, v102
  v_dot2_f32_bf16 v103, v167, v167, v103
  v_dot2_f32_bf16 v88, v168, s32, v88
  v_dot2_f32_bf16 v89, v168, v168, v89
  v_dot2_f32_bf16 v102, v169, s32, v102
  v_dot2_f32_bf16 v103, v169, v169, v103
  v_dot2_f32_bf16 v88, v170, s32, v88
  v_dot2_f32_bf16 v89, v170, v170, v89
  v_dot2_f32_bf16 v102, v171, s32, v102
  v_dot2_f32_bf16 v103, v171, v171, v103
  s_waitcnt vmcnt(0)
  v_cmp_eq_u32 vcc, 1, v116
  s_nop 0
  s_cmp_eq_u64 vcc, -1
  s_cbranch_scc1 L_g0_8
  s_cmp_lg_u32 s3, 0
  s_cbranch_scc1 L_wd_9
  s_cmp_lg_u32 s60, 0
  s_cbranch_scc1 L_wd_9
  v_lshlrev_b32 v4, 2, v2
  v_add_u32 v4, 0, v4
  s_mov_b32 exec_lo, 0x00000001
  s_mov_b32 exec_hi, 0x00000000
  s_mov_b32 s58, 0
L_poll_10:
  buffer_load_dword v7, v4, s[16:19], 0 offen sc1
  s_waitcnt vmcnt(0)
  v_cmp_eq_u32 vcc, 1, v7
  s_add_u32 s58, s58, 1
  s_cmp_eq_u64 vcc, exec
  s_cbranch_scc1 L_wd_9_d
  s_cmp_lt_u32 s58, 60000
  s_cbranch_scc1 L_poll_10
  s_or_b32 s60, s60, 1
L_wd_9_d:
  s_mov_b64 exec, -1
L_wd_9:
L_g0_8:
  s_lshr_b32 s33, s77, 1
  s_mul_i32 s33, s33, 384
  s_add_u32 s33, s33, 21504
  v_mul_u32_u24 v7, 37, v2
  v_lshrrev_b32 v7, 8, v7
  v_mul_u32_u24 v4, 7, v7
  v_sub_u32 v4, v2, v4
  v_lshlrev_b32 v4, 2, v4
  v_lshl_add_u32 v4, v7, 7, v4
  v_add_u32 v4, s33, v4
  s_cmp_lg_u32 s3, 0
  s_cbranch_scc1 L_wd_11
  s_cmp_lg_u32 s60, 0
  s_cbranch_scc1 L_wd_11
  s_mov_b32 exec_lo, 0x001fffff
  s_mov_b32 exec_hi, 0x00000000
  s_mov_b32 s58, 0
L_poll_12:
  buffer_load_dword v7, v4, s[8:11], 0 offen sc1
  s_waitcnt vmcnt(0)
  v_cmp_eq_u32 vcc, 1, v7
  s_add_u32 s58, s58, 1
  s_cmp_eq_u64 vcc, exec
  s_cbranch_scc1 L_wd_11_d
  s_cmp_lt_u32 s58, 60000
  s_cbranch_scc1 L_poll_12
  s_or_b32 s60, s60, 1
L_wd_11_d:
  s_mov_b64 exec, -1
L_wd_11:
  s_barrier
  v_and_b32 v116, 3, v2
  v_bfe_u32 v117, v2, 4, 1
  v_lshl_or_b32 v116, v117, 4, v116
  v_bfe_u32 v117, v2, 2, 1
  v_lshl_or_b32 v116, v117, 3, v116
  v_bfe_u32 v117, v2, 3, 1
  v_lshl_or_b32 v116, v117, 2, v116
  v_lshlrev_b32 v117, 2, v116
  s_lshr_b32 s33, s77, 1
  s_mul_i32 s33, s33, 3
  s_min_u32 s34, s3, 2
  s_add_u32 s33, s33, s34
  s_mul_i32 s33, s33, 3584
  s_and_b32 s34, s77, 1
  s_lshl_b32 s34, s34, 7
  s_add_u32 s33, s33, s34
  s_add_u32 s33, s33, 45064192
  s_mul_i32 s96, s77, 87
  s_mul_i32 s97, s3, 7
  s_add_u32 s96, s96, s97
  s_lshl_b32 s96, s96, 10
  s_add_u32 s96, s96, 65536
  s_mul_i32 s97, s3, 7280
  s_add_u32 s97, s97, 53248
  s_mov_b64 exec, s[100:101]
  ds_write_b128 v30, a[128:131] offset:0
  ds_write_b128 v30, a[132:135] offset:64
  ds_write_b128 v30, a[136:139] offset:128
  ds_write_b128 v30, a[140:143] offset:192
  ds_write_b128 v30, a[144:147] offset:256
  ds_write_b128 v30, a[148:151] offset:320
  ds_write_b128 v30, a[152:155] offset:384
  ds_write_b128 v30, a[156:159] offset:448
  s_mov_b64 exec, -1
  buffer_load_dword v118, v117, s[8:11], s33 offen offset:0 sc1
  ds_read_b128 v[200:203], v31 offset:0
  ds_read_b128 v[204:207], v31 offset:1088
  ds_read_b128 v[208:211], v31 offset:2176
  buffer_load_dword v119, v117, s[8:11], s33 offen offset:256 sc1
  ds_read_b128 v[212:215], v31 offset:3264
  ds_read_b128 v[216:219], v31 offset:4352
  ds_read_b128 v[220:223], v31 offset:5440
  ds_read_b128 v[224:227], v31 offset:6528
  buffer_load_dword v120, v117, s[8:11], s33 offen offset:512 sc1
  s_waitcnt lgkmcnt(15)
  v_dot2_f32_bf16 v88, v172, s32, v88
  v_dot2_f32_bf16 v89, v172, v172, v89
  v_dot2_f32_bf16 v102, v173, s32, v102
  buffer_load_dword v121, v117, s[8:11], s33 offen offset:768 sc1
  v_dot2_f32_bf16 v103, v173, v173, v103
  v_dot2_f32_bf16 v88, v174, s32, v88
  v_dot2_f32_bf16 v89, v174, v174, v89
  v_dot2_f32_bf16 v102, v175, s32, v102
  buffer_load_dword v122, v117, s[8:11], s33 offen offset:1024 sc1
  v_dot2_f32_bf16 v103, v175, v175, v103
  v_dot2_f32_bf16 v88, v176, s32, v88
  v_dot2_f32_bf16 v89, v176, v176, v89
  buffer_load_dword v123, v117, s[8:11], s33 offen offset:1280 sc1
  v_dot2_f32_bf16 v102, v177, s32, v102
  v_dot2_f32_bf16 v103, v177, v177, v103
  v_dot2_f32_bf16 v88, v178, s32, v88
  v_dot2_f32_bf16 v89, v178, v178, v89
  buffer_load_dword v124, v117, s[8:11], s33 offen offset:1536 sc1
  v_dot2_f32_bf16 v102, v179, s32, v102
  v_dot2_f32_bf16 v103, v179, v179, v103
  v_dot2_f32_bf16 v88, v180, s32, v88
  buffer_load_dword v125, v117, s[8:11], s33 offen offset:1792 sc1
  v_dot2_f32_bf16 v89, v180, v180, v89
  v_dot2_f32_bf16 v102, v181, s32, v102
  v_dot2_f32_bf16 v103, v181, v181, v103
  v_dot2_f32_bf16 v88, v182, s32, v88
  buffer_load_dword v126, v117, s[8:11], s33 offen offset:2048 sc1
  v_dot2_f32_bf16 v89, v182, v182, v89
  v_dot2_f32_bf16 v102, v183, s32, v102
  v_dot2_f32_bf16 v103, v183, v183, v103
  buffer_load_dword v127, v117, s[8:11], s33 offen offset:2304 sc1
  v_dot2_f32_bf16 v88, v184, s32, v88
  v_dot2_f32_bf16 v89, v184, v184, v89
  v_dot2_f32_bf16 v102, v185, s32, v102
  v_dot2_f32_bf16 v103, v185, v185, v103
  buffer_load_dword v128, v117, s[8:11], s33 offen offset:2560 sc1
  v_dot2_f32_bf16 v88, v186, s32, v88
  v_dot2_f32_bf16 v89, v186, v186, v89
  v_dot2_f32_bf16 v102, v187, s32, v102
  buffer_load_dword v129, v117, s[8:11], s33 offen offset:2816 sc1
  v_dot2_f32_bf16 v103, v187, v187, v103
  v_dot2_f32_bf16 v88, v188, s32, v88
  v_dot2_f32_bf16 v89, v188, v188, v89
  v_dot2_f32_bf16 v102, v189, s32, v102
  buffer_load_dword v130, v117, s[8:11], s33 offen offset:3072 sc1
  v_dot2_f32_bf16 v103, v189, v189, v103
  v_dot2_f32_bf16 v88, v190, s32, v88
  v_dot2_f32_bf16 v89, v190, v190, v89
  buffer_load_dword v131, v117, s[8:11], s33 offen offset:3328 sc1
  v_dot2_f32_bf16 v102, v191, s32, v102
  v_dot2_f32_bf16 v103, v191, v191, v103
  v_dot2_f32_bf16 v88, v192, s32, v88
  v_dot2_f32_bf16 v89, v192, v192, v89
  s_add_u32 s98, s96, 0
  s_add_u32 m0, s97, 0
  s_nop 0
  buffer_load_dwordx4 v1, s[8:11], s98 offen offset:0 sc1 lds
  v_dot2_f32_bf16 v102, v193, s32, v102
  v_dot2_f32_bf16 v103, v193, v193, v103
  v_dot2_f32_bf16 v88, v194, s32, v88
  s_add_u32 m0, s97, 16
  s_nop 0
  buffer_load_dwordx4 v1, s[8:11], s98 offen offset:1024 sc1 lds
  v_dot2_f32_bf16 v89, v194, v194, v89
  v_dot2_f32_bf16 v102, v195, s32, v102
  v_dot2_f32_bf16 v103, v195, v195, v103
  v_dot2_f32_bf16 v88, v196, s32, v88
  s_add_u32 m0, s97, 32
  s_nop 0
  buffer_load_dwordx4 v1, s[8:11], s98 offen offset:2048 sc1 lds
  v_dot2_f32_bf16 v89, v196, v196, v89
  v_dot2_f32_bf16 v102, v197, s32, v102
  v_dot2_f32_bf16 v103, v197, v197, v103
  s_add_u32 m0, s97, 48
  s_nop 0
  buffer_load_dwordx4 v1, s[8:11], s98 offen offset:3072 sc1 lds
  v_dot2_f32_bf16 v88, v198, s32, v88
  v_dot2_f32_bf16 v89, v198, v198, v89
  v_dot2_f32_bf16 v102, v199, s32, v102
  v_dot2_f32_bf16 v103, v199, v199, v103
  s_mov_b64 exec, s[100:101]
  ds_write_b128 v30, a[160:163] offset:0
  ds_write_b128 v30, a[164:167] offset:64
  ds_write_b128 v30, a[168:171] offset:128
  ds_write_b128 v30, a[172:175] offset:192
  ds_write_b128 v30, a[176:179] offset:256
  ds_write_b128 v30, a[180:183] offset:320
  ds_write_b128 v30, a[184:187] offset:384
  ds_write_b128 v30, a[188:191] offset:448
  s_mov_b64 exec, -1
  s_add_u32 s98, s96, 4096
  s_add_u32 m0, s97, 4160
  s_nop 0
  buffer_load_dwordx4 v1, s[8:11], s98 offen offset:0 sc1 lds
  ds_read_b128 v[228:231], v31 offset:0
  ds_read_b128 v[232:235], v31 offset:1088
  ds_read_b128 v[236:239], v31 offset:2176
  s_add_u32 m0, s97, 4176
  s_nop 0
  buffer_load_dwordx4 v1, s[8:11], s98 offen offset:1024 sc1 lds
  ds_read_b128 v[240:243], v31 offset:3264
  ds_read_b128 v[244:247], v31 offset:4352
  ds_read_b128 v[248:251], v31 offset:5440
  ds_read_b128 v[252:255], v31 offset:6528
  s_add_u32 m0, s97, 4192
  s_nop 0
  buffer_load_dwordx4 v1, s[8:11], s98 offen offset:2048 sc1 lds
  s_waitcnt lgkmcnt(15)
  v_dot2_f32_bf16 v88, v200, s32, v88
  v_dot2_f32_bf16 v89, v200, v200, v89
  v_dot2_f32_bf16 v102, v201, s32, v102
  v_dot2_f32_bf16 v103, v201, v201, v103
  s_add_u32 s98, s96, 29696
  s_add_u32 m0, s97, 30160
  s_nop 0
  buffer_load_dwordx4 v1, s[8:11], s98 offen offset:0 sc1 lds
  v_dot2_f32_bf16 v88, v202, s32, v88
  v_dot2_f32_bf16 v89, v202, v202, v89
  v_dot2_f32_bf16 v102, v203, s32, v102
  s_add_u32 m0, s97, 30176
  s_nop 0
  buffer_load_dwordx4 v1, s[8:11], s98 offen offset:1024 sc1 lds
  v_dot2_f32_bf16 v103, v203, v203, v103
  v_dot2_f32_bf16 v88, v204, s32, v88
  v_dot2_f32_bf16 v89, v204, v204, v89
  v_dot2_f32_bf16 v102, v205, s32, v102
  s_add_u32 m0, s97, 30192
  s_nop 0
  buffer_load_dwordx4 v1, s[8:11], s98 offen offset:2048 sc1 lds
  v_dot2_f32_bf16 v103, v205, v205, v103
  v_dot2_f32_bf16 v88, v206, s32, v88
  v_dot2_f32_bf16 v89, v206, v206, v89
  v_dot2_f32_bf16 v102, v207, s32, v102
  s_add_u32 m0, s97, 30208
  s_nop 0
  buffer_load_dwordx4 v1, s[8:11], s98 offen offset:3072 sc1 lds
  v_dot2_f32_bf16 v103, v207, v207, v103
  v_dot2_f32_bf16 v88, v208, s32, v88
  v_dot2_f32_bf16 v89, v208, v208, v89
  s_add_u32 s98, s96, 33792
  s_add_u32 m0, s97, 34320
  s_nop 0
  buffer_load_dwordx4 v1, s[8:11], s98 offen offset:0 sc1 lds
  v_dot2_f32_bf16 v102, v209, s32, v102
  v_dot2_f32_bf16 v103, v209, v209, v103
  v_dot2_f32_bf16 v88, v210, s32, v88
  v_dot2_f32_bf16 v89, v210, v210, v89
  s_add_u32 m0, s97, 34336
  s_nop 0
  buffer_load_dwordx4 v1, s[8:11], s98 offen offset:1024 sc1 lds
  v_dot2_f32_bf16 v102, v211, s32, v102
  v_dot2_f32_bf16 v103, v211, v211, v103
  v_dot2_f32_bf16 v88, v212, s32, v88
  v_dot2_f32_bf16 v89, v212, v212, v89
  s_add_u32 m0, s97, 34352
  s_nop 0
  buffer_load_dwordx4 v1, s[8:11], s98 offen offset:2048 sc1 lds
  v_dot2_f32_bf16 v102, v213, s32, v102
  v_dot2_f32_bf16 v103, v213, v213, v103
  v_dot2_f32_bf16 v88, v214, s32, v88
  v_dot2_f32_bf16 v89, v214, v214, v89
  s_add_u32 s98, s96, 59392
  s_add_u32 m0, s97, 60320
  s_nop 0
  buffer_load_dwordx4 v1, s[8:11], s98 offen offset:0 sc1 lds
  v_dot2_f32_bf16 v102, v215, s32, v102
  v_dot2_f32_bf16 v103, v215, v215, v103
  v_dot2_f32_bf16 v88, v216, s32, v88
  s_add_u32 m0, s97, 60336
  s_nop 0
  buffer_load_dwordx4 v1, s[8:11], s98 offen offset:1024 sc1 lds
  v_dot2_f32_bf16 v89, v216, v216, v89
  v_dot2_f32_bf16 v102, v217, s32, v102
  v_dot2_f32_bf16 v103, v217, v217, v103
  v_dot2_f32_bf16 v88, v218, s32, v88
  s_add_u32 m0, s97, 60352
  s_nop 0
  buffer_load_dwordx4 v1, s[8:11], s98 offen offset:2048 sc1 lds
  v_dot2_f32_bf16 v89, v218, v218, v89
  v_dot2_f32_bf16 v102, v219, s32, v102
  v_dot2_f32_bf16 v103, v219, v219, v103
  v_dot2_f32_bf16 v88, v220, s32, v88
  s_add_u32 m0, s97, 60368
  s_nop 0
  buffer_load_dwordx4 v1, s[8:11], s98 offen offset:3072 sc1 lds
  v_dot2_f32_bf16 v89, v220, v220, v89
  v_dot2_f32_bf16 v102, v221, s32, v102
  v_dot2_f32_bf16 v103, v221, v221, v103
  s_add_u32 s98, s96, 63488
  s_add_u32 m0, s97, 64480
  s_nop 0
  buffer_load_dwordx4 v1, s[8:11], s98 offen offset:0 sc1 lds
  v_dot2_f32_bf16 v88, v222, s32, v88
  v_dot2_f32_bf16 v89, v222, v222, v89
  v_dot2_f32_bf16 v102, v223, s32, v102
  v_dot2_f32_bf16 v103, v223, v223, v103
  s_add_u32 m0, s97, 64496
  s_nop 0
  buffer_load_dwordx4 v1, s[8:11], s98 offen offset:1024 sc1 lds
  v_dot2_f32_bf16 v88, v224, s32, v88
  v_dot2_f32_bf16 v89, v224, v224, v89
  v_dot2_f32_bf16 v102, v225, s32, v102
  v_dot2_f32_bf16 v103, v225, v225, v103
  s_add_u32 m0, s97, 64512
  s_nop 0
  buffer_load_dwordx4 v1, s[8:11], s98 offen offset:2048 sc1 lds
  v_dot2_f32_bf16 v88, v226, s32, v88
  v_dot2_f32_bf16 v89, v226, v226, v89
  v_dot2_f32_bf16 v102, v227, s32, v102
  v_dot2_f32_bf16 v103, v227, v227, v103
  s_waitcnt lgkmcnt(6)
  v_dot2_f32_bf16 v88, v228, s32, v88
  v_dot2_f32_bf16 v89, v228, v228, v89
  v_dot2_f32_bf16 v102, v229, s32, v102
  v_dot2_f32_bf16 v103, v229, v229, v103
  v_dot2_f32_bf16 v88, v230, s32, v88
  v_dot2_f32_bf16 v89, v230, v230, v89
  v_dot2_f32_bf16 v102, v231, s32, v102
  v_dot2_f32_bf16 v103, v231, v231, v103
  s_waitcnt lgkmcnt(5)
  v_dot2_f32_bf16 v88, v232, s32, v88
  v_dot2_f32_bf16 v89, v232, v232, v89
  v_dot2_f32_bf16 v102, v233, s32, v102
  v_dot2_f32_bf16 v103, v233, v233, v103
  v_dot2_f32_bf16 v88, v234, s32, v88
  v_dot2_f32_bf16 v89, v234, v234, v89
  v_dot2_f32_bf16 v102, v235, s32, v102
  v_dot2_f32_bf16 v103, v235, v235, v103
  s_waitcnt lgkmcnt(4)
  v_dot2_f32_bf16 v88, v236, s32, v88
  v_dot2_f32_bf16 v89, v236, v236, v89
  v_dot2_f32_bf16 v102, v237, s32, v102
  v_dot2_f32_bf16 v103, v237, v237, v103
  v_dot2_f32_bf16 v88, v238, s32, v88
  v_dot2_f32_bf16 v89, v238, v238, v89
  v_dot2_f32_bf16 v102, v239, s32, v102
  v_dot2_f32_bf16 v103, v239, v239, v103
  s_waitcnt lgkmcnt(3)
  v_dot2_f32_bf16 v88, v240, s32, v88
  v_dot2_f32_bf16 v89, v240, v240, v89
  v_dot2_f32_bf16 v102, v241, s32, v102
  v_dot2_f32_bf16 v103, v241, v241, v103
  v_dot2_f32_bf16 v88, v242, s32, v88
  v_dot2_f32_bf16 v89, v242, v242, v89
  v_dot2_f32_bf16 v102, v243, s32, v102
  v_dot2_f32_bf16 v103, v243, v243, v103
  s_waitcnt lgkmcnt(2)
  v_dot2_f32_bf16 v88, v244, s32, v88
  v_dot2_f32_bf16 v89, v244, v244, v89
  v_dot2_f32_bf16 v102, v245, s32, v102
  v_dot2_f32_bf16 v103, v245, v245, v103
  v_dot2_f32_bf16 v88, v246, s32, v88
  v_dot2_f32_bf16 v89, v246, v246, v89
  v_dot2_f32_bf16 v102, v247, s32, v102
  v_dot2_f32_bf16 v103, v247, v247, v103
  s_waitcnt lgkmcnt(1)
  v_dot2_f32_bf16 v88, v248, s32, v88
  v_dot2_f32_bf16 v89, v248, v248, v89
  v_dot2_f32_bf16 v102, v249, s32, v102
  v_dot2_f32_bf16 v103, v249, v249, v103
  v_dot2_f32_bf16 v88, v250, s32, v88
  v_dot2_f32_bf16 v89, v250, v250, v89
  v_dot2_f32_bf16 v102, v251, s32, v102
  v_dot2_f32_bf16 v103, v251, v251, v103
  s_waitcnt lgkmcnt(0)
  v_dot2_f32_bf16 v88, v252, s32, v88
  v_dot2_f32_bf16 v89, v252, v252, v89
  v_dot2_f32_bf16 v102, v253, s32, v102
  v_dot2_f32_bf16 v103, v253, v253, v103
  v_dot2_f32_bf16 v88, v254, s32, v88
  v_dot2_f32_bf16 v89, v254, v254, v89
  v_dot2_f32_bf16 v102, v255, s32, v102
  v_dot2_f32_bf16 v103, v255, v255, v103
  s_nop 1
  v_add_f32 v88, v88, v102
  v_add_f32 v89, v89, v103
  s_cmp_eq_u32 s3, 3
  s_cbranch_scc1 L_nob_13
  s_mul_i32 s34, s3, 30160
  s_add_u32 s34, s34, 82368
  s_waitcnt vmcnt(27)
  v_add_f32 v118, v118, v125
  s_waitcnt vmcnt(26)
  v_add_f32 v119, v119, v126
  s_waitcnt vmcnt(25)
  v_add_f32 v120, v120, v127
  s_waitcnt vmcnt(24)
  v_add_f32 v121, v121, v128
  s_waitcnt vmcnt(23)
  v_add_f32 v122, v122, v129
  s_waitcnt vmcnt(22)
  v_add_f32 v123, v123, v130
  s_waitcnt vmcnt(21)
  v_add_f32 v124, v124, v131
  v_add_f32 v118, v118, v122
  v_add_f32 v119, v119, v123
  v_add_f32 v120, v120, v124
  v_add_f32 v118, v118, v120
  v_add_f32 v119, v119, v121
  v_add_f32 v118, v118, v119
  v_mov_b32 v135, 0
  v_cvt_pk_bf16_f32 v119, v118, v118
  v_lshlrev_b32 v120, 16, v119
  v_sub_f32 v120, v118, v120
  v_cvt_pk_bf16_f32 v120, v120, v120
  v_perm_b32 v136, v120, v119, s30
  v_perm_b32 v137, v135, v119, s30
  v_mov_b32 v138, v135
  v_mov_b32 v139, 0
  v_cndmask_b32 v136, 0, v136, s[64:65]
  v_cndmask_b32 v137, 0, v137, s[64:65]
  v_cndmask_b32 v138, 0, v138, s[64:65]
  v_add_u32 v117, s34, v1
  ds_write_b128 v117, v[136:139]
L_nob_13:
  s_waitcnt vmcnt(0) lgkmcnt(0)
  v_lshrrev_b32 v16, 5, v2
  v_bfe_u32 v17, v2, 2, 3
  v_and_b32 v18, 3, v2
  s_mov_b32 s86, 3
  s_mov_b32 s94, 0
  s_mov_b32 s95, 0x00020000
  s_load_dwordx2 s[92:93], s[0:1], 40
  s_cmp_ge_u32 s2, 126
  s_cbranch_scc1 L_jno_18
  s_mov_b32 s39, 0x00020000
  s_mov_b32 s88, 0
  s_cmp_ge_u32 s2, 56
  s_cbranch_scc1 L_j1_14
  s_load_dwordx2 s[36:37], s[0:1], 32
  s_mov_b32 s38, 1605632
  s_sub_u32 s86, s86, 3
  s_mov_b32 s44, 3584
  s_lshl_b32 s45, s2, 6
  s_mov_b32 s88, s45
  s_mov_b32 s94, 3584
  s_mul_i32 s85, s2, 29696
  s_add_u32 s85, s85, 1949696
  s_add_u32 s87, s85, 28672
  s_mul_i32 s46, s3, 7168
  s_add_u32 s85, s85, s46
  s_branch L_jgo_17
L_j1_14:
  s_cmp_ge_u32 s2, 112
  s_cbranch_scc1 L_j2_15
  s_load_dwordx2 s[36:37], s[0:1], 48
  s_mov_b32 s38, 1605632
  s_sub_u32 s86, s86, 2
  s_mov_b32 s44, 896
  s_sub_u32 s46, s2, 56
  s_lshr_b32 s47, s46, 2
  s_and_b32 s46, s46, 3
  s_mul_i32 s45, s46, 401408
  s_lshl_b32 s56, s47, 6
  s_add_u32 s45, s45, s56
  s_mul_i32 s85, s47, 114688
  s_mul_i32 s56, s46, 28672
  s_add_u32 s85, s85, s56
  s_add_u32 s85, s85, 3612672
  s_mul_i32 s46, s3, 7168
  s_add_u32 s85, s85, s46
  s_branch L_jgo_17
L_j2_15:
  s_load_dwordx2 s[36:37], s[0:1], 16
  s_mov_b32 s38, 401408
  s_sub_u32 s86, s86, 1
  s_mov_b32 s44, 896
  s_sub_u32 s47, s2, 112
  s_lshl_b32 s45, s47, 6
  s_mul_i32 s85, s47, 32768
  s_add_u32 s85, s85, 1490944
  s_lshl_b32 s46, s3, 13
  s_add_u32 s85, s85, s46
L_jgo_17:
  v_lshlrev_b32 v22, 4, v17
  v_lshrrev_b32 v23, 1, v17
  v_mul_u32_u24 v23, 28, v23
  v_and_b32 v19, 1, v17
  v_lshl_add_u32 v23, v19, 4, v23
  s_cmp_eq_u32 s86, 2
  s_cselect_b64 s[56:57], -1, 0
  v_cndmask_b32 v22, v22, v23, s[56:57]
  v_lshl_add_u32 v22, v16, 3, v22
  v_mul_lo_u32 v22, v22, s44
  v_lshl_add_u32 v22, v18, 4, v22
  v_and_b32 v19, v19, v16
  v_cmp_eq_u32 vcc, 1, v19
  s_nop 0
  s_and_b64 s[56:57], s[56:57], vcc
  v_mov_b32 v23, 0x40000000
  v_cndmask_b32 v23, v22, v23, s[56:57]
  s_mul_i32 s46, s3, s44
  s_mul_i32 s46, s46, 112
  s_add_u32 s45, s45, s46
  s_cmp_eq_u32 s86, 2
  s_cselect_b64 s[90:91], -1, s[72:73]
  s_waitcnt lgkmcnt(0)
  s_mov_b64 exec, s[90:91]
  buffer_load_dwordx4 a[0:3], v22, s[36:39], s45 offen
  s_add_u32 s45, s45, s44
  buffer_load_dwordx4 a[4:7], v22, s[36:39], s45 offen
  s_add_u32 s45, s45, s44
  buffer_load_dwordx4 a[8:11], v22, s[36:39], s45 offen
  s_add_u32 s45, s45, s44
  buffer_load_dwordx4 a[12:15], v22, s[36:39], s45 offen
  s_add_u32 s45, s45, s44
  buffer_load_dwordx4 a[16:19], v23, s[36:39], s45 offen
  s_add_u32 s45, s45, s44
  buffer_load_dwordx4 a[20:23], v23, s[36:39], s45 offen
  s_add_u32 s45, s45, s44
  buffer_load_dwordx4 a[24:27], v23, s[36:39], s45 offen
  s_add_u32 s45, s45, s44
  buffer_load_dwordx4 a[28:31], v23, s[36:39], s45 offen
  s_mov_b64 exec, -1
  v_and_b32 v22, 3, v2
  v_bfe_u32 v23, v2, 4, 1
  v_lshl_or_b32 v22, v23, 4, v22
  v_bfe_u32 v23, v2, 2, 1
  v_lshl_or_b32 v22, v23, 3, v22
  v_bfe_u32 v23, v2, 3, 1
  v_lshl_or_b32 v22, v23, 2, v22
  v_lshlrev_b32 v22, 1, v22
  buffer_load_ushort a32, v22, s[92:95], s88 offen
L_jno_18:
L_layer:
  s_mul_i32 s68, s6, 15794176
  s_add_u32 s68, s68, 13475840
  s_lshl_b32 s84, s6, 11
  s_lshl_b32 s32, s76, 2
  s_add_u32 s32, s32, s3
  s_cmp_eq_u32 s6, 0
  s_cbranch_scc1 L_q_main
  s_lshl_b32 s34, s76, 7
  s_add_u32 s34, s34, 16384
  s_cmp_lg_u32 s3, 0
  s_cbranch_scc1 L_wd_19
  s_cmp_lg_u32 s60, 0
  s_cbranch_scc1 L_wd_19
  v_lshlrev_b32 v4, 2, v2
  v_add_u32 v4, s34, v4
  s_mov_b32 exec_lo, 0x00003fff
  s_mov_b32 exec_hi, 0x00000000
  s_mov_b32 s58, 0
L_poll_20:
  buffer_load_dword v7, v4, s[8:11], 0 offen sc1
  s_waitcnt vmcnt(0)
  v_cmp_eq_u32 vcc, 1, v7
  s_add_u32 s58, s58, 1
  s_cmp_eq_u64 vcc, exec
  s_cbranch_scc1 L_wd_19_d
  s_cmp_lt_u32 s58, 60000
  s_cbranch_scc1 L_poll_20
  s_or_b32 s60, s60, 1
L_wd_19_d:
  s_mov_b64 exec, -1
L_wd_19:
  s_waitcnt vmcnt(0) lgkmcnt(0)
  s_barrier
  s_mul_i32 s35, s32, 3584
  s_add_u32 s36, s35, 5677056
  v_and_b32 v4, 31, v2
  v_lshlrev_b32 v4, 3, v4
  v_lshrrev_b32 v7, 5, v2
  v_lshl_add_u32 v4, v7, 8, v4
  buffer_load_dwordx2 v[88:89], v4, s[8:11], s36 offen offset:0 sc1
  buffer_load_dwordx2 v[90:91], v4, s[8:11], s36 offen offset:512 sc1
  buffer_load_dwordx2 v[92:93], v4, s[8:11], s36 offen offset:1024 sc1
  buffer_load_dwordx2 v[94:95], v4, s[8:11], s36 offen offset:1536 sc1
  buffer_load_dwordx2 v[96:97], v4, s[8:11], s36 offen offset:2048 sc1
  buffer_load_dwordx2 v[98:99], v4, s[8:11], s36 offen offset:2560 sc1
  buffer_load_dwordx2 v[100:101], v4, s[8:11], s36 offen offset:3072 sc1
  s_mul_i32 s35, s32, 28672
  s_add_u32 s40, s35, 9805824
  s_add_u32 s41, s40, 4096
  s_add_u32 s42, s40, 8192
  s_add_u32 s43, s40, 12288
  s_add_u32 s44, s40, 16384
  s_add_u32 s45, s40, 20480
  s_add_u32 s46, s40, 24576
  buffer_load_dwordx4 v[144:147], v1, s[8:11], s40 offen offset:0 sc1
  buffer_load_dwordx4 v[148:151], v1, s[8:11], s40 offen offset:1024 sc1
  buffer_load_dwordx4 v[152:155], v1, s[8:11], s40 offen offset:2048 sc1
  buffer_load_dwordx4 v[156:159], v1, s[8:11], s40 offen offset:3072 sc1
  buffer_load_dwordx4 v[160:163], v1, s[8:11], s41 offen offset:0 sc1
  buffer_load_dwordx4 v[164:167], v1, s[8:11], s41 offen offset:1024 sc1
  buffer_load_dwordx4 v[168:171], v1, s[8:11], s41 offen offset:2048 sc1
  buffer_load_dwordx4 v[172:175], v1, s[8:11], s41 offen offset:3072 sc1
L_q_main:
  s_barrier
  s_mov_b32 s33, 0x3f803f80
  s_cmp_lg_u32 s6, 0
  s_cbranch_scc1 L_qz_21
  s_cmp_lg_u32 s76, 0
  s_cbranch_scc1 L_qsv_22
  s_cmp_eq_u32 s3, 3
  s_cbranch_scc1 L_qsv_22
  s_mul_i32 s35, s3, 29
  s_add_u32 s35, s35, 28
  s_mul_i32 s36, s35, 1040
  s_add_u32 s36, s36, 53248
  v_add_u32 v4, s36, v1
  ds_read_b128 v[104:107], v4
  s_mul_i32 s36, s77, 87
  s_add_u32 s36, s36, s35
  s_lshl_b32 s36, s36, 10
  s_add_u32 s36, s36, 65536
  s_waitcnt lgkmcnt(0)
  buffer_store_dwordx4 v[104:107], v1, s[8:11], s36 offen sc1
  s_nop 1
L_qsv_22:
L_qz_21:
  s_cmp_lg_u32 s6, 0
  ds_read_b128 v[64:67], v1 offset:53248
  ds_read_b128 v[68:71], v5 offset:17872
  ds_read_b128 v[72:75], v5 offset:48032
  ds_read_b128 v[76:79], v1 offset:54288
  ds_read_b128 v[80:83], v5 offset:18912
  ds_read_b128 v[84:87], v5 offset:49072
  ds_read_b128 v[128:131], v1 offset:55328
  ds_read_b128 v[132:135], v5 offset:19952
  ds_read_b128 v[136:139], v5 offset:50112
  s_cbranch_scc0 L_qx_23
  buffer_load_dwordx4 v[176:179], v1, s[8:11], s42 offen offset:0 sc1
L_qx_23:
  s_waitcnt vmcnt(8) lgkmcnt(8)
  v_mfma_f32_32x32x16_bf16 v[16:31], v[64:67], v[144:147], 0
  s_waitcnt lgkmcnt(7)
  v_mfma_f32_32x32x16_bf16 v[32:47], v[68:71], v[144:147], 0
  s_waitcnt lgkmcnt(6)
  v_mfma_f32_32x32x16_bf16 v[48:63], v[144:147], v[72:75], 0
  ds_read_b128 v[64:67], v1 offset:56368
  ds_read_b128 v[68:71], v5 offset:20992
  ds_read_b128 v[72:75], v5 offset:51152
  s_cbranch_scc0 L_qx_24
  buffer_load_dwordx4 v[180:183], v1, s[8:11], s42 offen offset:1024 sc1
L_qx_24:
  s_waitcnt vmcnt(8) lgkmcnt(8)
  v_mfma_f32_32x32x16_bf16 v[16:31], v[76:79], v[148:151], v[16:31]
  s_waitcnt lgkmcnt(7)
  v_mfma_f32_32x32x16_bf16 v[32:47], v[80:83], v[148:151], v[32:47]
  s_waitcnt lgkmcnt(6)
  v_mfma_f32_32x32x16_bf16 v[48:63], v[148:151], v[84:87], v[48:63]
  ds_read_b128 v[76:79], v1 offset:57408
  ds_read_b128 v[80:83], v5 offset:22032
  ds_read_b128 v[84:87], v5 offset:52192
  s_cbranch_scc0 L_qx_25
  buffer_load_dwordx4 v[184:187], v1, s[8:11], s42 offen offset:2048 sc1
L_qx_25:
  s_waitcnt vmcnt(8) lgkmcnt(8)
  v_mfma_f32_32x32x16_bf16 v[16:31], v[128:131], v[152:155], v[16:31]
  s_waitcnt lgkmcnt(7)
  v_mfma_f32_32x32x16_bf16 v[32:47], v[132:135], v[152:155], v[32:47]
  s_waitcnt lgkmcnt(6)
  v_mfma_f32_32x32x16_bf16 v[48:63], v[152:155], v[136:139], v[48:63]
  ds_read_b128 v[128:131], v1 offset:58448
  ds_read_b128 v[132:135], v5 offset:23072
  ds_read_b128 v[136:139], v5 offset:53232
  s_cbranch_scc0 L_qx_26
  buffer_load_dwordx4 v[188:191], v1, s[8:11], s42 offen offset:3072 sc1
L_qx_26:
  s_waitcnt vmcnt(8) lgkmcnt(8)
  v_mfma_f32_32x32x16_bf16 v[16:31], v[64:67], v[156:159], v[16:31]
  s_waitcnt lgkmcnt(7)
  v_mfma_f32_32x32x16_bf16 v[32:47], v[68:71], v[156:159], v[32:47]
  s_waitcnt lgkmcnt(6)
  v_mfma_f32_32x32x16_bf16 v[48:63], v[156:159], v[72:75], v[48:63]
  ds_read_b128 v[64:67], v1 offset:59488
  ds_read_b128 v[68:71], v5 offset:24112
  ds_read_b128 v[72:75], v5 offset:54272
  s_cbranch_scc0 L_qx_27
  buffer_load_dwordx4 v[192:195], v1, s[8:11], s43 offen offset:0 sc1
L_qx_27:
  s_waitcnt vmcnt(8) lgkmcnt(8)
  v_mfma_f32_32x32x16_bf16 v[16:31], v[76:79], v[160:163], v[16:31]
  s_waitcnt lgkmcnt(7)
  v_mfma_f32_32x32x16_bf16 v[32:47], v[80:83], v[160:163], v[32:47]
  s_waitcnt lgkmcnt(6)
  v_mfma_f32_32x32x16_bf16 v[48:63], v[160:163], v[84:87], v[48:63]
  ds_read_b128 v[76:79], v1 offset:60528
  ds_read_b128 v[80:83], v5 offset:25152
  ds_read_b128 v[84:87], v5 offset:55312
  s_cbranch_scc0 L_qx_28
  buffer_load_dwordx4 v[196:199], v1, s[8:11], s43 offen offset:1024 sc1
L_qx_28:
  s_waitcnt vmcnt(8) lgkmcnt(8)
  v_mfma_f32_32x32x16_bf16 v[16:31], v[128:131], v[164:167], v[16:31]
  s_waitcnt lgkmcnt(7)
  v_mfma_f32_32x32x16_bf16 v[32:47], v[132:135], v[164:167], v[32:47]
  s_waitcnt lgkmcnt(6)
  v_mfma_f32_32x32x16_bf16 v[48:63], v[164:167], v[136:139], v[48:63]
  ds_read_b128 v[128:131], v1 offset:61568
  ds_read_b128 v[132:135], v5 offset:26192
  ds_read_b128 v[136:139], v5 offset:56352
  s_cbranch_scc0 L_qx_29
  buffer_load_dwordx4 v[200:203], v1, s[8:11], s43 offen offset:2048 sc1
L_qx_29:
  s_waitcnt vmcnt(8) lgkmcnt(8)
  v_mfma_f32_32x32x16_bf16 v[16:31], v[64:67], v[168:171], v[16:31]
  s_waitcnt lgkmcnt(7)
  v_mfma_f32_32x32x16_bf16 v[32:47], v[68:71], v[168:171], v[32:47]
  s_waitcnt lgkmcnt(6)
  v_mfma_f32_32x32x16_bf16 v[48:63], v[168:171], v[72:75], v[48:63]
  ds_read_b128 v[64:67], v1 offset:62608
  ds_read_b128 v[68:71], v5 offset:27232
  ds_read_b128 v[72:75], v5 offset:57392
  s_cbranch_scc0 L_qx_30
  buffer_load_dwordx4 v[204:207], v1, s[8:11], s43 offen offset:3072 sc1
L_qx_30:
  s_waitcnt vmcnt(8) lgkmcnt(8)
  v_mfma_f32_32x32x16_bf16 v[16:31], v[76:79], v[172:175], v[16:31]
  s_waitcnt lgkmcnt(7)
  v_mfma_f32_32x32x16_bf16 v[32:47], v[80:83], v[172:175], v[32:47]
  s_waitcnt lgkmcnt(6)
  v_mfma_f32_32x32x16_bf16 v[48:63], v[172:175], v[84:87], v[48:63]
  ds_read_b128 v[76:79], v1 offset:63648
  ds_read_b128 v[80:83], v5 offset:28272
  ds_read_b128 v[84:87], v5 offset:58432
  s_cbranch_scc0 L_qx_31
  buffer_load_dwordx4 v[208:211], v1, s[8:11], s44 offen offset:0 sc1
L_qx_31:
  s_waitcnt vmcnt(8) lgkmcnt(8)
  v_mfma_f32_32x32x16_bf16 v[16:31], v[128:131], v[176:179], v[16:31]
  s_waitcnt lgkmcnt(7)
  v_mfma_f32_32x32x16_bf16 v[32:47], v[132:135], v[176:179], v[32:47]
  s_waitcnt lgkmcnt(6)
  v_mfma_f32_32x32x16_bf16 v[48:63], v[176:179], v[136:139], v[48:63]
  ds_read_b128 v[128:131], v1 offset:64688
  ds_read_b128 v[132:135], v5 offset:29312
  ds_read_b128 v[136:139], v5 offset:59472
  s_cbranch_scc0 L_qx_32
  buffer_load_dwordx4 v[212:215], v1, s[8:11], s44 offen offset:1024 sc1
L_qx_32:
  s_waitcnt vmcnt(8) lgkmcnt(8)
  v_mfma_f32_32x32x16_bf16 v[16:31], v[64:67], v[180:183], v[16:31]
  s_waitcnt lgkmcnt(7)
  v_mfma_f32_32x32x16_bf16 v[32:47], v[68:71], v[180:183], v[32:47]
  s_waitcnt lgkmcnt(6)
  v_mfma_f32_32x32x16_bf16 v[48:63], v[180:183], v[72:75], v[48:63]
  ds_read_b128 v[64:67], v5 offset:192
  ds_read_b128 v[68:71], v5 offset:30352
  ds_read_b128 v[72:75], v5 offset:60512
  s_cbranch_scc0 L_qx_33
  buffer_load_dwordx4 v[216:219], v1, s[8:11], s44 offen offset:2048 sc1
L_qx_33:
  s_waitcnt vmcnt(8) lgkmcnt(8)
  v_mfma_f32_32x32x16_bf16 v[16:31], v[76:79], v[184:187], v[16:31]
  s_waitcnt lgkmcnt(7)
  v_mfma_f32_32x32x16_bf16 v[32:47], v[80:83], v[184:187], v[32:47]
  s_waitcnt lgkmcnt(6)
  v_mfma_f32_32x32x16_bf16 v[48:63], v[184:187], v[84:87], v[48:63]
  ds_read_b128 v[76:79], v5 offset:1232
  ds_read_b128 v[80:83], v5 offset:31392
  ds_read_b128 v[84:87], v5 offset:61552
  s_cbranch_scc0 L_qx_34
  buffer_load_dwordx4 v[220:223], v1, s[8:11], s44 offen offset:3072 sc1
L_qx_34:
  s_waitcnt vmcnt(8) lgkmcnt(8)
  v_mfma_f32_32x32x16_bf16 v[16:31], v[128:131], v[188:191], v[16:31]
  s_waitcnt lgkmcnt(7)
  v_mfma_f32_32x32x16_bf16 v[32:47], v[132:135], v[188:191], v[32:47]
  s_waitcnt lgkmcnt(6)
  v_mfma_f32_32x32x16_bf16 v[48:63], v[188:191], v[136:139], v[48:63]
  ds_read_b128 v[128:131], v5 offset:2272
  ds_read_b128 v[132:135], v5 offset:32432
  ds_read_b128 v[136:139], v5 offset:62592
  s_cbranch_scc0 L_qx_35
  buffer_load_dwordx4 v[224:227], v1, s[8:11], s45 offen offset:0 sc1
L_qx_35:
  s_waitcnt vmcnt(8) lgkmcnt(8)
  v_mfma_f32_32x32x16_bf16 v[16:31], v[64:67], v[192:195], v[16:31]
  s_waitcnt lgkmcnt(7)
  v_mfma_f32_32x32x16_bf16 v[32:47], v[68:71], v[192:195], v[32:47]
  s_waitcnt lgkmcnt(6)
  v_mfma_f32_32x32x16_bf16 v[48:63], v[192:195], v[72:75], v[48:63]
  ds_read_b128 v[64:67], v5 offset:3312
  ds_read_b128 v[68:71], v5 offset:33472
  ds_read_b128 v[72:75], v5 offset:63632
  s_cbranch_scc0 L_qx_36
  buffer_load_dwordx4 v[228:231], v1, s[8:11], s45 offen offset:1024 sc1
L_qx_36:
  s_waitcnt vmcnt(8) lgkmcnt(8)
  v_mfma_f32_32x32x16_bf16 v[16:31], v[76:79], v[196:199], v[16:31]
  s_waitcnt lgkmcnt(7)
  v_mfma_f32_32x32x16_bf16 v[32:47], v[80:83], v[196:199], v[32:47]
  s_waitcnt lgkmcnt(6)
  v_mfma_f32_32x32x16_bf16 v[48:63], v[196:199], v[84:87], v[48:63]
  ds_read_b128 v[76:79], v5 offset:4352
  ds_read_b128 v[80:83], v5 offset:34512
  ds_read_b128 v[84:87], v5 offset:64672
  s_cbranch_scc0 L_qx_37
  buffer_load_dwordx4 v[232:235], v1, s[8:11], s45 offen offset:2048 sc1
L_qx_37:
  s_waitcnt vmcnt(8) lgkmcnt(8)
  v_mfma_f32_32x32x16_bf16 v[16:31], v[128:131], v[200:203], v[16:31]
  s_waitcnt lgkmcnt(7)
  v_mfma_f32_32x32x16_bf16 v[32:47], v[132:135], v[200:203], v[32:47]
  s_waitcnt lgkmcnt(6)
  v_mfma_f32_32x32x16_bf16 v[48:63], v[200:203], v[136:139], v[48:63]
  ds_read_b128 v[128:131], v5 offset:5392
  ds_read_b128 v[132:135], v5 offset:35552
  ds_read_b128 v[136:139], v6 offset:176
  s_cbranch_scc0 L_qx_38
  buffer_load_dwordx4 v[236:239], v1, s[8:11], s45 offen offset:3072 sc1
L_qx_38:
  s_waitcnt vmcnt(8) lgkmcnt(8)
  v_mfma_f32_32x32x16_bf16 v[16:31], v[64:67], v[204:207], v[16:31]
  s_waitcnt lgkmcnt(7)
  v_mfma_f32_32x32x16_bf16 v[32:47], v[68:71], v[204:207], v[32:47]
  s_waitcnt lgkmcnt(6)
  v_mfma_f32_32x32x16_bf16 v[48:63], v[204:207], v[72:75], v[48:63]
  ds_read_b128 v[64:67], v5 offset:6432
  ds_read_b128 v[68:71], v5 offset:36592
  ds_read_b128 v[72:75], v6 offset:1216
  s_cbranch_scc0 L_qx_39
  buffer_load_dwordx4 v[240:243], v1, s[8:11], s46 offen offset:0 sc1
L_qx_39:
  s_waitcnt vmcnt(8) lgkmcnt(8)
  v_mfma_f32_32x32x16_bf16 v[16:31], v[76:79], v[208:211], v[16:31]
  s_waitcnt lgkmcnt(7)
  v_mfma_f32_32x32x16_bf16 v[32:47], v[80:83], v[208:211], v[32:47]
  s_waitcnt lgkmcnt(6)
  v_mfma_f32_32x32x16_bf16 v[48:63], v[208:211], v[84:87], v[48:63]
  ds_read_b128 v[76:79], v5 offset:7472
  ds_read_b128 v[80:83], v5 offset:37632
  ds_read_b128 v[84:87], v6 offset:2256
  s_cbranch_scc0 L_qx_40
  buffer_load_dwordx4 v[244:247], v1, s[8:11], s46 offen offset:1024 sc1
L_qx_40:
  s_waitcnt vmcnt(8) lgkmcnt(8)
  v_mfma_f32_32x32x16_bf16 v[16:31], v[128:131], v[212:215], v[16:31]
  s_waitcnt lgkmcnt(7)
  v_mfma_f32_32x32x16_bf16 v[32:47], v[132:135], v[212:215], v[32:47]
  s_waitcnt lgkmcnt(6)
  v_mfma_f32_32x32x16_bf16 v[48:63], v[212:215], v[136:139], v[48:63]
  ds_read_b128 v[128:131], v5 offset:8512
  ds_read_b128 v[132:135], v5 offset:38672
  ds_read_b128 v[136:139], v6 offset:3296
  s_cbranch_scc0 L_qx_41
  buffer_load_dwordx4 v[248:251], v1, s[8:11], s46 offen offset:2048 sc1
L_qx_41:
  s_waitcnt vmcnt(8) lgkmcnt(8)
  v_mfma_f32_32x32x16_bf16 v[16:31], v[64:67], v[216:219], v[16:31]
  s_waitcnt lgkmcnt(7)
  v_mfma_f32_32x32x16_bf16 v[32:47], v[68:71], v[216:219], v[32:47]
  s_waitcnt lgkmcnt(6)
  v_mfma_f32_32x32x16_bf16 v[48:63], v[216:219], v[72:75], v[48:63]
  ds_read_b128 v[64:67], v5 offset:9552
  ds_read_b128 v[68:71], v5 offset:39712
  ds_read_b128 v[72:75], v6 offset:4336
  s_cbranch_scc0 L_qx_42
  buffer_load_dwordx4 v[252:255], v1, s[8:11], s46 offen offset:3072 sc1
L_qx_42:
  s_waitcnt vmcnt(8) lgkmcnt(8)
  v_mfma_f32_32x32x16_bf16 v[16:31], v[76:79], v[220:223], v[16:31]
  s_waitcnt lgkmcnt(7)
  v_mfma_f32_32x32x16_bf16 v[32:47], v[80:83], v[220:223], v[32:47]
  s_waitcnt lgkmcnt(6)
  v_mfma_f32_32x32x16_bf16 v[48:63], v[220:223], v[84:87], v[48:63]
  ds_read_b128 v[76:79], v5 offset:10592
  ds_read_b128 v[80:83], v5 offset:40752
  ds_read_b128 v[84:87], v6 offset:5376
  s_waitcnt vmcnt(7) lgkmcnt(8)
  v_mfma_f32_32x32x16_bf16 v[16:31], v[128:131], v[224:227], v[16:31]
  s_waitcnt lgkmcnt(7)
  v_mfma_f32_32x32x16_bf16 v[32:47], v[132:135], v[224:227], v[32:47]
  s_waitcnt lgkmcnt(6)
  v_mfma_f32_32x32x16_bf16 v[48:63], v[224:227], v[136:139], v[48:63]
  ds_read_b128 v[128:131], v5 offset:11632
  ds_read_b128 v[132:135], v5 offset:41792
  ds_read_b128 v[136:139], v6 offset:6416
  s_waitcnt vmcnt(6) lgkmcnt(8)
  v_mfma_f32_32x32x16_bf16 v[16:31], v[64:67], v[228:231], v[16:31]
  s_waitcnt lgkmcnt(7)
  v_mfma_f32_32x32x16_bf16 v[32:47], v[68:71], v[228:231], v[32:47]
  s_waitcnt lgkmcnt(6)
  v_mfma_f32_32x32x16_bf16 v[48:63], v[228:231], v[72:75], v[48:63]
  ds_read_b128 v[64:67], v5 offset:12672
  ds_read_b128 v[68:71], v5 offset:42832
  ds_read_b128 v[72:75], v6 offset:7456
  s_waitcnt vmcnt(5) lgkmcnt(8)
  v_mfma_f32_32x32x16_bf16 v[16:31], v[76:79], v[232:235], v[16:31]
  s_waitcnt lgkmcnt(7)
  v_mfma_f32_32x32x16_bf16 v[32:47], v[80:83], v[232:235], v[32:47]
  s_waitcnt lgkmcnt(6)
  v_mfma_f32_32x32x16_bf16 v[48:63], v[232:235], v[84:87], v[48:63]
  ds_read_b128 v[76:79], v5 offset:13712
  ds_read_b128 v[80:83], v5 offset:43872
  ds_read_b128 v[84:87], v6 offset:8496
  s_waitcnt vmcnt(4) lgkmcnt(8)
  v_mfma_f32_32x32x16_bf16 v[16:31], v[128:131], v[236:239], v[16:31]
  s_waitcnt lgkmcnt(7)
  v_mfma_f32_32x32x16_bf16 v[32:47], v[132:135], v[236:239], v[32:47]
  s_waitcnt lgkmcnt(6)
  v_mfma_f32_32x32x16_bf16 v[48:63], v[236:239], v[136:139], v[48:63]
  ds_read_b128 v[128:131], v5 offset:14752
  ds_read_b128 v[132:135], v5 offset:44912
  ds_read_b128 v[136:139], v6 offset:9536
  s_waitcnt vmcnt(3) lgkmcnt(8)
  v_mfma_f32_32x32x16_bf16 v[16:31], v[64:67], v[240:243], v[16:31]
  s_waitcnt lgkmcnt(7)
  v_mfma_f32_32x32x16_bf16 v[32:47], v[68:71], v[240:243], v[32:47]
  s_waitcnt lgkmcnt(6)
  v_mfma_f32_32x32x16_bf16 v[48:63], v[240:243], v[72:75], v[48:63]
  ds_read_b128 v[64:67], v5 offset:15792
  ds_read_b128 v[68:71], v5 offset:45952
  ds_read_b128 v[72:75], v6 offset:10576
  s_waitcnt vmcnt(2) lgkmcnt(8)
  v_mfma_f32_32x32x16_bf16 v[16:31], v[76:79], v[244:247], v[16:31]
  s_waitcnt lgkmcnt(7)
  v_mfma_f32_32x32x16_bf16 v[32:47], v[80:83], v[244:247], v[32:47]
  s_waitcnt lgkmcnt(6)
  v_mfma_f32_32x32x16_bf16 v[48:63], v[244:247], v[84:87], v[48:63]
  ds_read_b128 v[76:79], v5 offset:16832
  ds_read_b128 v[80:83], v5 offset:46992
  ds_read_b128 v[84:87], v6 offset:11616
  s_waitcnt vmcnt(1) lgkmcnt(8)
  v_mfma_f32_32x32x16_bf16 v[16:31], v[128:131], v[248:251], v[16:31]
  s_waitcnt lgkmcnt(7)
  v_mfma_f32_32x32x16_bf16 v[32:47], v[132:135], v[248:251], v[32:47]
  s_waitcnt lgkmcnt(6)
  v_mfma_f32_32x32x16_bf16 v[48:63], v[248:251], v[136:139], v[48:63]
  s_waitcnt vmcnt(0) lgkmcnt(5)
  v_mfma_f32_32x32x16_bf16 v[16:31], v[64:67], v[252:255], v[16:31]
  s_waitcnt lgkmcnt(4)
  v_mfma_f32_32x32x16_bf16 v[32:47], v[68:71], v[252:255], v[32:47]
  s_waitcnt lgkmcnt(3)
  v_mfma_f32_32x32x16_bf16 v[48:63], v[252:255], v[72:75], v[48:63]
  s_cbranch_scc0 L_qs_43
  v_add_f32 v88, v88, v90
  v_add_f32 v89, v89, v91
  v_add_f32 v88, v88, v92
  v_add_f32 v89, v89, v93
  v_add_f32 v88, v88, v94
  v_add_f32 v89, v89, v95
  v_add_f32 v88, v88, v96
  v_add_f32 v89, v89, v97
  v_add_f32 v88, v88, v98
  v_add_f32 v89, v89, v99
  v_add_f32 v88, v88, v100
  v_add_f32 v89, v89, v101
L_qs_43:
  v_mov_b32 v104, v88
  s_nop 1
  v_permlane32_swap_b32 v88, v104
  v_add_f32 v88, v88, v104
  v_mov_b32 v104, v89
  s_nop 1
  v_permlane32_swap_b32 v89, v104
  v_add_f32 v89, v89, v104
  v_mul_f32 v88, 0x3b124925, v88
  v_mul_f32 v89, 0x3b124925, v89
  v_fma_f32 v89, -v88, v88, v89
  v_max_f32 v89, 0, v89
  v_add_f32 v89, 0x3727c5ac, v89
  v_rsq_f32 v14, v89
  v_sub_f32 v88, 0, v88
  v_cvt_pk_bf16_f32 v10, v88, v88
  v_mul_f32 v89, v89, v14
  v_lshlrev_b32 v104, 16, v10
  v_sub_f32 v104, v88, v104
  v_cvt_pk_bf16_f32 v11, v104, v89
  v_and_b32 v104, 0xffff0000, v11
  v_sub_f32 v104, v89, v104
  v_cvt_pk_bf16_f32 v12, v104, 0
  v_mov_b32 v13, 0
  v_cndmask_b32 v10, 0, v10, s[64:65]
  v_cndmask_b32 v11, 0, v11, s[64:65]
  v_cndmask_b32 v12, 0, v12, s[64:65]
  s_lshl_b32 s37, s3, 7
  s_add_u32 s37, s37, 49152
  v_and_b32 v103, 31, v2
  v_lshlrev_b32 v103, 2, v103
  v_add_u32 v103, s37, v103
  ds_write_b32 v103, v14
  v_lshrrev_b32 v103, 5, v2
  v_lshlrev_b32 v103, 4, v103
  v_add_u32 v103, s37, v103
  ds_read_b128 v[112:115], v103 offset:0
  ds_read_b128 v[116:119], v103 offset:32
  ds_read_b128 v[120:123], v103 offset:64
  ds_read_b128 v[124:127], v103 offset:96
  s_waitcnt lgkmcnt(7)
  v_mfma_f32_32x32x16_bf16 v[16:31], v[76:79], v[10:13], v[16:31]
  s_waitcnt lgkmcnt(6)
  v_mfma_f32_32x32x16_bf16 v[32:47], v[80:83], v[10:13], v[32:47]
  s_waitcnt lgkmcnt(5)
  v_mfma_f32_32x32x16_bf16 v[48:63], v[10:13], v[84:87], v[48:63]
  s_lshl_b32 s38, s77, 6
  s_add_u32 s38, s38, s32
  s_lshl_b32 s39, s38, 11
  s_add_u32 s39, s39, s68
  s_add_u32 s39, s39, 0
  s_lshl_b32 s40, s38, 12
  s_add_u32 s40, s40, s68
  s_add_u32 s40, s40, 2097152
  v_mul_f32 v15, 0x3e8b97f6, v14
  v_pk_mul_f32 v[16:17], v[16:17], v[14:15] op_sel:[0,1] op_sel_hi:[1,1]
  v_pk_mul_f32 v[18:19], v[18:19], v[14:15] op_sel:[0,1] op_sel_hi:[1,1]
  v_pk_mul_f32 v[20:21], v[20:21], v[14:15] op_sel:[0,1] op_sel_hi:[1,1]
  v_pk_mul_f32 v[22:23], v[22:23], v[14:15] op_sel:[0,1] op_sel_hi:[1,1]
  v_pk_mul_f32 v[24:25], v[24:25], v[14:15] op_sel:[0,1] op_sel_hi:[1,1]
  v_pk_mul_f32 v[26:27], v[26:27], v[14:15] op_sel:[0,1] op_sel_hi:[1,1]
  v_pk_mul_f32 v[28:29], v[28:29], v[14:15] op_sel:[0,1] op_sel_hi:[1,1]
  v_pk_mul_f32 v[30:31], v[30:31], v[14:15] op_sel:[0,1] op_sel_hi:[1,1]
  v_cvt_pk_bf16_f32 v128, v16, v17
  v_cvt_pk_bf16_f32 v129, v18, v19
  v_cvt_pk_bf16_f32 v130, v20, v21
  v_cvt_pk_bf16_f32 v131, v22, v23
  v_cvt_pk_bf16_f32 v132, v24, v25
  v_cvt_pk_bf16_f32 v133, v26, v27
  v_cvt_pk_bf16_f32 v134, v28, v29
  v_cvt_pk_bf16_f32 v135, v30, v31
  v_cndmask_b32 v134, 0, v134, s[64:65]
  v_cndmask_b32 v135, 0, v135, s[64:65]
  buffer_store_dwordx4 v[128:131], v1, s[8:11], s39 offen offset:0 sc1
  buffer_store_dwordx4 v[132:135], v1, s[8:11], s39 offen offset:1024 sc1
  v_pk_mul_f32 v[32:33], v[32:33], v[14:15] op_sel:[0,0] op_sel_hi:[1,0]
  v_pk_mul_f32 v[34:35], v[34:35], v[14:15] op_sel:[0,0] op_sel_hi:[1,0]
  v_pk_mul_f32 v[36:37], v[36:37], v[14:15] op_sel:[0,0] op_sel_hi:[1,0]
  v_pk_mul_f32 v[38:39], v[38:39], v[14:15] op_sel:[0,0] op_sel_hi:[1,0]
  v_pk_mul_f32 v[40:41], v[40:41], v[14:15] op_sel:[0,0] op_sel_hi:[1,0]
  v_pk_mul_f32 v[42:43], v[42:43], v[14:15] op_sel:[0,0] op_sel_hi:[1,0]
  v_pk_mul_f32 v[44:45], v[44:45], v[14:15] op_sel:[0,0] op_sel_hi:[1,0]
  v_pk_mul_f32 v[46:47], v[46:47], v[14:15] op_sel:[0,0] op_sel_hi:[1,0]
  v_cvt_pk_bf16_f32 v136, v32, v33
  v_cvt_pk_bf16_f32 v137, v34, v35
  v_cvt_pk_bf16_f32 v138, v36, v37
  v_cvt_pk_bf16_f32 v139, v38, v39
  v_cvt_pk_bf16_f32 v140, v40, v41
  v_cvt_pk_bf16_f32 v141, v42, v43
  v_cvt_pk_bf16_f32 v142, v44, v45
  v_cvt_pk_bf16_f32 v143, v46, v47
  buffer_store_dwordx4 v[136:139], v1, s[8:11], s40 offen offset:0 sc1
  buffer_store_dwordx4 v[140:143], v1, s[8:11], s40 offen offset:1024 sc1
  s_waitcnt lgkmcnt(3)
  v_pk_mul_f32 v[48:49], v[48:49], v[112:113]
  v_pk_mul_f32 v[50:51], v[50:51], v[114:115]
  s_waitcnt lgkmcnt(2)
  v_pk_mul_f32 v[52:53], v[52:53], v[116:117]
  v_pk_mul_f32 v[54:55], v[54:55], v[118:119]
  s_waitcnt lgkmcnt(1)
  v_pk_mul_f32 v[56:57], v[56:57], v[120:121]
  v_pk_mul_f32 v[58:59], v[58:59], v[122:123]
  s_waitcnt lgkmcnt(0)
  v_pk_mul_f32 v[60:61], v[60:61], v[124:125]
  v_pk_mul_f32 v[62:63], v[62:63], v[126:127]
  v_cvt_pk_bf16_f32 v88, v48, v49
  v_cvt_pk_bf16_f32 v89, v50, v51
  v_cvt_pk_bf16_f32 v90, v52, v53
  v_cvt_pk_bf16_f32 v91, v54, v55
  v_cvt_pk_bf16_f32 v92, v56, v57
  v_cvt_pk_bf16_f32 v93, v58, v59
  v_cvt_pk_bf16_f32 v94, v60, v61
  v_cvt_pk_bf16_f32 v95, v62, v63
  v_mov_b32 v104, 0x3f803f80
  v_cndmask_b32 v88, v88, v104, s[66:67]
  v_cndmask_b32 v89, v89, v104, s[66:67]
  v_cndmask_b32 v90, v90, v104, s[66:67]
  v_cndmask_b32 v91, v91, v104, s[66:67]
  v_cndmask_b32 v92, v92, v104, s[66:67]
  v_cndmask_b32 v93, v93, v104, s[66:67]
  v_cndmask_b32 v94, v94, v104, s[66:67]
  v_cndmask_b32 v95, v95, v104, s[66:67]
  buffer_store_dwordx4 v[88:91], v1, s[8:11], s40 offen offset:2048 sc1
  buffer_store_dwordx4 v[92:95], v1, s[8:11], s40 offen offset:3072 sc1
  s_cmp_lg_u32 s6, 0
  s_cbranch_scc1 L_qr_44
  s_lshl_b32 s34, s4, 7
  s_lshl_b32 s35, s5, 2
  s_add_u32 s34, s34, s35
  s_add_u32 s34, s34, 32768
  v_mov_b32 v4, s34
  v_mov_b32 v7, s59
  buffer_store_dword v7, v4, s[8:11], 0 offen sc1
L_qr_44:
  s_lshl_b32 s34, s77, 7
  s_add_u32 s34, s34, s84
  s_lshl_b32 s35, s76, 2
  s_add_u32 s34, s34, s35
  s_add_u32 s34, s34, 0
  s_waitcnt vmcnt(0) lgkmcnt(0)
  s_barrier
  s_cmp_lg_u32 s3, 0
  s_cbranch_scc1 L_sig_45
  v_mov_b32 v4, s34
  s_mov_b64 exec, 1
  buffer_store_dword v3, v4, s[8:11], 0 offen sc1
  s_mov_b64 exec, -1
L_sig_45:
  s_cmp_lg_u32 s6, 0
  s_cbranch_scc1 L_nojob_46
  s_cmp_eq_u32 s86, 3
  s_cbranch_scc1 L_nojob_46
  v_lshrrev_b32 v16, 5, v2
  v_bfe_u32 v17, v2, 2, 3
  v_and_b32 v18, 3, v2
  s_mov_b32 s30, 0x05040100
  s_mov_b32 s31, 0x07060302
  s_mov_b32 s32, 0x3f803f80
  v_accvgpr_read_b32 v48, a0
  v_accvgpr_read_b32 v49, a1
  v_accvgpr_read_b32 v50, a2
  v_accvgpr_read_b32 v51, a3
  v_accvgpr_read_b32 v52, a4
  v_accvgpr_read_b32 v53, a5
  v_accvgpr_read_b32 v54, a6
  v_accvgpr_read_b32 v55, a7
  v_accvgpr_read_b32 v56, a8
  v_accvgpr_read_b32 v57, a9
  v_accvgpr_read_b32 v58, a10
  v_accvgpr_read_b32 v59, a11
  v_accvgpr_read_b32 v60, a12
  v_accvgpr_read_b32 v61, a13
  v_accvgpr_read_b32 v62, a14
  v_accvgpr_read_b32 v63, a15
  v_accvgpr_read_b32 v64, a16
  v_accvgpr_read_b32 v65, a17
  v_accvgpr_read_b32 v66, a18
  v_accvgpr_read_b32 v67, a19
  v_accvgpr_read_b32 v68, a20
  v_accvgpr_read_b32 v69, a21
  v_accvgpr_read_b32 v70, a22
  v_accvgpr_read_b32 v71, a23
  v_accvgpr_read_b32 v72, a24
  v_accvgpr_read_b32 v73, a25
  v_accvgpr_read_b32 v74, a26
  v_accvgpr_read_b32 v75, a27
  v_accvgpr_read_b32 v76, a28
  v_accvgpr_read_b32 v77, a29
  v_accvgpr_read_b32 v78, a30
  v_accvgpr_read_b32 v79, a31
  s_cmp_eq_u32 s86, 2
  s_cselect_b32 s33, 8, 7
  s_mul_i32 s33, s33, s3
  s_mul_i32 s33, s33, 1040
  v_mul_u32_u24 v24, 1040, v17
  v_lshl_add_u32 v24, v16, 9, v24
  v_lshrrev_b32 v19, 1, v18
  v_lshl_add_u32 v24, v19, 8, v24
  v_and_b32 v19, 1, v18
  v_lshl_add_u32 v24, v19, 6, v24
  v_add_u32 v24, s33, v24
  v_add_u32 v25, 0x80, v24
  s_lshl_b32 s35, s3, 9
  s_add_u32 s35, s35, 40960
  v_lshrrev_b32 v19, 4, v2
  v_lshlrev_b32 v26, 7, v19
  v_lshl_add_u32 v26, v18, 5, v26
  v_add_u32 v26, s35, v26
  v_add_u32 v27, 16, v26
  v_mov_b32 v16, 0
  v_mov_b32 v17, 0
  v_mov_b32 v18, 0
  v_mov_b32 v19, 0
  v_mov_b32 v20, 0
  v_mov_b32 v21, 0
  v_mov_b32 v22, 0
  v_mov_b32 v23, 0
  s_mov_b64 exec, s[90:91]
  v_perm_b32 v32, v52, v48, s30
  v_perm_b32 v33, v60, v56, s30
  v_perm_b32 v34, v68, v64, s30
  v_perm_b32 v35, v76, v72, s30
  v_perm_b32 v36, v52, v48, s31
  v_perm_b32 v37, v60, v56, s31
  v_perm_b32 v38, v68, v64, s31
  v_perm_b32 v39, v76, v72, s31
  v_perm_b32 v40, v53, v49, s30
  v_perm_b32 v41, v61, v57, s30
  v_perm_b32 v42, v69, v65, s30
  v_perm_b32 v43, v77, v73, s30
  v_perm_b32 v44, v53, v49, s31
  v_perm_b32 v45, v61, v57, s31
  v_perm_b32 v46, v69, v65, s31
  v_perm_b32 v47, v77, v73, s31
  ds_write_b128 v24, v[32:35] offset:0
  ds_write_b128 v24, v[36:39] offset:16
  ds_write_b128 v24, v[40:43] offset:32
  ds_write_b128 v24, v[44:47] offset:48
  v_dot2_f32_bf16 v16, v32, s32, v16
  v_dot2_f32_bf16 v17, v36, s32, v17
  v_dot2_f32_bf16 v18, v40, s32, v18
  v_dot2_f32_bf16 v19, v44, s32, v19
  v_dot2_f32_bf16 v16, v33, s32, v16
  v_dot2_f32_bf16 v17, v37, s32, v17
  v_dot2_f32_bf16 v18, v41, s32, v18
  v_dot2_f32_bf16 v19, v45, s32, v19
  v_dot2_f32_bf16 v16, v34, s32, v16
  v_dot2_f32_bf16 v17, v38, s32, v17
  v_dot2_f32_bf16 v18, v42, s32, v18
  v_dot2_f32_bf16 v19, v46, s32, v19
  v_dot2_f32_bf16 v16, v35, s32, v16
  v_dot2_f32_bf16 v17, v39, s32, v17
  v_dot2_f32_bf16 v18, v43, s32, v18
  v_dot2_f32_bf16 v19, v47, s32, v19
  v_perm_b32 v32, v54, v50, s30
  v_perm_b32 v33, v62, v58, s30
  v_perm_b32 v34, v70, v66, s30
  v_perm_b32 v35, v78, v74, s30
  v_perm_b32 v36, v54, v50, s31
  v_perm_b32 v37, v62, v58, s31
  v_perm_b32 v38, v70, v66, s31
  v_perm_b32 v39, v78, v74, s31
  v_perm_b32 v40, v55, v51, s30
  v_perm_b32 v41, v63, v59, s30
  v_perm_b32 v42, v71, v67, s30
  v_perm_b32 v43, v79, v75, s30
  v_perm_b32 v44, v55, v51, s31
  v_perm_b32 v45, v63, v59, s31
  v_perm_b32 v46, v71, v67, s31
  v_perm_b32 v47, v79, v75, s31
  ds_write_b128 v25, v[32:35] offset:0
  ds_write_b128 v25, v[36:39] offset:16
  ds_write_b128 v25, v[40:43] offset:32
  ds_write_b128 v25, v[44:47] offset:48
  v_dot2_f32_bf16 v20, v32, s32, v20
  v_dot2_f32_bf16 v21, v36, s32, v21
  v_dot2_f32_bf16 v22, v40, s32, v22
  v_dot2_f32_bf16 v23, v44, s32, v23
  v_dot2_f32_bf16 v20, v33, s32, v20
  v_dot2_f32_bf16 v21, v37, s32, v21
  v_dot2_f32_bf16 v22, v41, s32, v22
  v_dot2_f32_bf16 v23, v45, s32, v23
  v_dot2_f32_bf16 v20, v34, s32, v20
  v_dot2_f32_bf16 v21, v38, s32, v21
  v_dot2_f32_bf16 v22, v42, s32, v22
  v_dot2_f32_bf16 v23, v46, s32, v23
  v_dot2_f32_bf16 v20, v35, s32, v20
  v_dot2_f32_bf16 v21, v39, s32, v21
  v_dot2_f32_bf16 v22, v43, s32, v22
  v_dot2_f32_bf16 v23, v47, s32, v23
  s_mov_b64 exec, -1
  v_add_f32_dpp v16, v16, v16 row_shr:4 row_mask:0xf bank_mask:0xf bound_ctrl:0
  v_add_f32_dpp v17, v17, v17 row_shr:4 row_mask:0xf bank_mask:0xf bound_ctrl:0
  v_add_f32_dpp v18, v18, v18 row_shr:4 row_mask:0xf bank_mask:0xf bound_ctrl:0
  v_add_f32_dpp v19, v19, v19 row_shr:4 row_mask:0xf bank_mask:0xf bound_ctrl:0
  v_add_f32_dpp v20, v20, v20 row_shr:4 row_mask:0xf bank_mask:0xf bound_ctrl:0
  v_add_f32_dpp v21, v21, v21 row_shr:4 row_mask:0xf bank_mask:0xf bound_ctrl:0
  v_add_f32_dpp v22, v22, v22 row_shr:4 row_mask:0xf bank_mask:0xf bound_ctrl:0
  v_add_f32_dpp v23, v23, v23 row_shr:4 row_mask:0xf bank_mask:0xf bound_ctrl:0
  v_add_f32_dpp v16, v16, v16 row_shr:8 row_mask:0xf bank_mask:0xf bound_ctrl:0
  v_add_f32_dpp v17, v17, v17 row_shr:8 row_mask:0xf bank_mask:0xf bound_ctrl:0
  v_add_f32_dpp v18, v18, v18 row_shr:8 row_mask:0xf bank_mask:0xf bound_ctrl:0
  v_add_f32_dpp v19, v19, v19 row_shr:8 row_mask:0xf bank_mask:0xf bound_ctrl:0
  v_add_f32_dpp v20, v20, v20 row_shr:8 row_mask:0xf bank_mask:0xf bound_ctrl:0
  v_add_f32_dpp v21, v21, v21 row_shr:8 row_mask:0xf bank_mask:0xf bound_ctrl:0
  v_add_f32_dpp v22, v22, v22 row_shr:8 row_mask:0xf bank_mask:0xf bound_ctrl:0
  v_add_f32_dpp v23, v23, v23 row_shr:8 row_mask:0xf bank_mask:0xf bound_ctrl:0
  s_mov_b64 exec, s[74:75]
  ds_write_b128 v26, v[16:19] offset:0
  ds_write_b128 v27, v[20:23] offset:0
  s_mov_b64 exec, -1
  s_waitcnt lgkmcnt(0)
  v_add_u32 v28, s33, v1
  ds_read_b128 v[80:83], v28 offset:0
  ds_read_b128 v[84:87], v28 offset:1040
  ds_read_b128 v[88:91], v28 offset:2080
  ds_read_b128 v[92:95], v28 offset:3120
  ds_read_b128 v[96:99], v28 offset:4160
  ds_read_b128 v[100:103], v28 offset:5200
  ds_read_b128 v[104:107], v28 offset:6240
  ds_read_b128 v[108:111], v28 offset:7280
  s_add_u32 s34, s85, 0
  s_waitcnt lgkmcnt(7)
  buffer_store_dwordx4 v[80:83], v1, s[8:11], s34 offen offset:0 sc1
  s_waitcnt lgkmcnt(6)
  buffer_store_dwordx4 v[84:87], v1, s[8:11], s34 offen offset:1024 sc1
  s_waitcnt lgkmcnt(5)
  buffer_store_dwordx4 v[88:91], v1, s[8:11], s34 offen offset:2048 sc1
  s_waitcnt lgkmcnt(4)
  buffer_store_dwordx4 v[92:95], v1, s[8:11], s34 offen offset:3072 sc1
  s_add_u32 s34, s85, 4096
  s_waitcnt lgkmcnt(3)
  buffer_store_dwordx4 v[96:99], v1, s[8:11], s34 offen offset:0 sc1
  s_waitcnt lgkmcnt(2)
  buffer_store_dwordx4 v[100:103], v1, s[8:11], s34 offen offset:1024 sc1
  s_waitcnt lgkmcnt(1)
  buffer_store_dwordx4 v[104:107], v1, s[8:11], s34 offen offset:2048 sc1
  s_cmp_lg_u32 s86, 2
  s_cbranch_scc1 L_j7_47
  s_waitcnt lgkmcnt(0)
  buffer_store_dwordx4 v[108:111], v1, s[8:11], s34 offen offset:3072 sc1
L_j7_47:
  s_barrier
  s_cmp_lg_u32 s86, 0
  s_cbranch_scc1 L_jx_48
  s_cmp_lg_u32 s3, 0
  s_cbranch_scc1 L_jx_48
  s_mov_b32 s34, 40960
  v_accvgpr_read_b32 v35, a32
  v_and_b32 v16, 3, v2
  v_bfe_u32 v17, v2, 4, 1
  v_lshl_or_b32 v16, v17, 4, v16
  v_bfe_u32 v17, v2, 2, 1
  v_lshl_or_b32 v16, v17, 3, v16
  v_bfe_u32 v17, v2, 3, 1
  v_lshl_or_b32 v16, v17, 2, v16
  v_lshl_add_u32 v17, v16, 2, s34
  ds_read_b32 v18, v17 offset:0
  ds_read_b32 v19, v17 offset:128
  ds_read_b32 v20, v17 offset:256
  ds_read_b32 v21, v17 offset:384
  ds_read_b32 v22, v17 offset:512
  ds_read_b32 v23, v17 offset:640
  ds_read_b32 v24, v17 offset:768
  ds_read_b32 v25, v17 offset:896
  ds_read_b32 v26, v17 offset:1024
  ds_read_b32 v27, v17 offset:1152
  ds_read_b32 v28, v17 offset:1280
  ds_read_b32 v29, v17 offset:1408
  ds_read_b32 v30, v17 offset:1536
  ds_read_b32 v31, v17 offset:1664
  ds_read_b32 v32, v17 offset:1792
  ds_read_b32 v33, v17 offset:1920
  s_waitcnt lgkmcnt(7)
  v_add_f32 v18, v18, v26
  s_waitcnt lgkmcnt(6)
  v_add_f32 v19, v19, v27
  s_waitcnt lgkmcnt(5)
  v_add_f32 v20, v20, v28
  s_waitcnt lgkmcnt(4)
  v_add_f32 v21, v21, v29
  s_waitcnt lgkmcnt(3)
  v_add_f32 v22, v22, v30
  s_waitcnt lgkmcnt(2)
  v_add_f32 v23, v23, v31
  s_waitcnt lgkmcnt(1)
  v_add_f32 v24, v24, v32
  s_waitcnt lgkmcnt(0)
  v_add_f32 v25, v25, v33
  v_add_f32 v18, v18, v22
  v_add_f32 v19, v19, v23
  v_add_f32 v20, v20, v24
  v_add_f32 v21, v21, v25
  v_add_f32 v18, v18, v20
  v_add_f32 v19, v19, v21
  v_add_f32 v18, v18, v19
  v_cvt_pk_bf16_f32 v19, v18, v18
  v_lshlrev_b32 v20, 16, v19
  v_sub_f32 v20, v18, v20
  v_cvt_pk_bf16_f32 v20, v20, v20
  v_perm_b32 v36, v20, v19, s30
  v_perm_b32 v37, v35, v19, s30
  v_mov_b32 v38, v35
  v_mov_b32 v39, 0
  v_cndmask_b32 v36, 0, v36, s[64:65]
  v_cndmask_b32 v37, 0, v37, s[64:65]
  v_cndmask_b32 v38, 0, v38, s[64:65]
  buffer_store_dwordx4 v[36:39], v1, s[8:11], s87 offen sc1
L_jx_48:
L_nojob_46:
  s_load_dwordx2 s[12:13], s[0:1], 72
  s_load_dwordx2 s[92:93], s[0:1], 72
  s_mov_b32 s15, 0x00020000
  s_mov_b32 s95, 0x00020000
L_att:
  s_lshl_b32 s34, s78, 7
  s_add_u32 s34, s34, s84
  s_add_u32 s34, s34, 0
  s_cmp_lg_u32 s3, 0
  s_cbranch_scc1 L_wd_49
  s_cmp_lg_u32 s60, 0
  s_cbranch_scc1 L_wd_49
  v_lshlrev_b32 v4, 2, v2
  v_add_u32 v4, s34, v4
  s_mov_b32 exec_lo, 0x0000ffff
  s_mov_b32 exec_hi, 0x00000000
  s_mov_b32 s58, 0
L_poll_50:
  buffer_load_dword v7, v4, s[8:11], 0 offen sc1
  s_waitcnt vmcnt(0)
  v_cmp_eq_u32 vcc, 1, v7
  s_add_u32 s58, s58, 1
  s_cmp_eq_u64 vcc, exec
  s_cbranch_scc1 L_wd_49_d
  s_cmp_lt_u32 s58, 60000
  s_cbranch_scc1 L_poll_50
  s_or_b32 s60, s60, 1
L_wd_49_d:
  s_mov_b64 exec, -1
L_wd_49:
  s_waitcnt vmcnt(0) lgkmcnt(0)
  s_barrier
  s_cmp_lg_u32 s6, 0
  s_cbranch_scc1 L_apf_51
  s_cmp_eq_u32 s86, 3
  s_cbranch_scc1 L_apf_51
  s_cmp_lg_u32 s3, 3
  s_cbranch_scc1 L_apf_51
  s_lshl_b32 s34, s2, 2
  s_add_u32 s34, s34, 20480
  v_mov_b32 v4, s34
  s_mov_b64 exec, 1
  buffer_store_dword v3, v4, s[8:11], 0 offen sc1
  s_mov_b64 exec, -1
L_apf_51:
  s_lshl_b32 s32, s78, 6
  s_lshl_b32 s33, s79, 2
  s_add_u32 s32, s32, s33
  s_lshl_b32 s36, s78, 6
  s_lshl_b32 s37, s3, 4
  s_add_u32 s36, s36, s37
  s_lshl_b32 s36, s36, 12
  s_add_u32 s36, s36, s68
  s_add_u32 s36, s36, 2097152
  s_mov_b32 s38, 0
L_att_re_52:
  s_mov_b32 s37, s36
  buffer_load_dwordx4 a[0:3], v1, s[8:11], s37 offen offset:0 sc1
  buffer_load_dwordx4 a[4:7], v1, s[8:11], s37 offen offset:1024 sc1
  s_xor_b32 s33, s3, 0
  s_add_u32 s33, s33, s32
  s_lshl_b32 s33, s33, 11
  s_add_u32 s33, s33, s68
  s_add_u32 s33, s33, 0
  buffer_load_dwordx4 v[16:19], v1, s[8:11], s33 offen offset:0 sc1
  buffer_load_dwordx4 v[20:23], v1, s[8:11], s33 offen offset:1024 sc1
  s_xor_b32 s33, s3, 1
  s_add_u32 s33, s33, s32
  s_lshl_b32 s33, s33, 11
  s_add_u32 s33, s33, s68
  s_add_u32 s33, s33, 0
  buffer_load_dwordx4 v[24:27], v1, s[8:11], s33 offen offset:0 sc1
  buffer_load_dwordx4 v[28:31], v1, s[8:11], s33 offen offset:1024 sc1
  s_xor_b32 s33, s3, 2
  s_add_u32 s33, s33, s32
  s_lshl_b32 s33, s33, 11
  s_add_u32 s33, s33, s68
  s_add_u32 s33, s33, 0
  buffer_load_dwordx4 v[32:35], v1, s[8:11], s33 offen offset:0 sc1
  buffer_load_dwordx4 v[36:39], v1, s[8:11], s33 offen offset:1024 sc1
  s_xor_b32 s33, s3, 3
  s_add_u32 s33, s33, s32
  s_lshl_b32 s33, s33, 11
  s_add_u32 s33, s33, s68
  s_add_u32 s33, s33, 0
  buffer_load_dwordx4 v[40:43], v1, s[8:11], s33 offen offset:0 sc1
  buffer_load_dwordx4 v[44:47], v1, s[8:11], s33 offen offset:1024 sc1
  buffer_load_dwordx4 a[8:11], v1, s[8:11], s37 offen offset:2048 sc1
  buffer_load_dwordx4 a[12:15], v1, s[8:11], s37 offen offset:3072 sc1
  s_add_u32 s37, s37, 4096
  buffer_load_dwordx4 a[16:19], v1, s[8:11], s37 offen offset:0 sc1
  buffer_load_dwordx4 a[20:23], v1, s[8:11], s37 offen offset:1024 sc1
  buffer_load_dwordx4 a[24:27], v1, s[8:11], s37 offen offset:2048 sc1
  buffer_load_dwordx4 a[28:31], v1, s[8:11], s37 offen offset:3072 sc1
  s_add_u32 s37, s37, 4096
  buffer_load_dwordx4 a[32:35], v1, s[8:11], s37 offen offset:0 sc1
  buffer_load_dwordx4 a[36:39], v1, s[8:11], s37 offen offset:1024 sc1
  buffer_load_dwordx4 a[40:43], v1, s[8:11], s37 offen offset:2048 sc1
  buffer_load_dwordx4 a[44:47], v1, s[8:11], s37 offen offset:3072 sc1
  s_add_u32 s37, s37, 4096
  v_min_u32 v218, 62, v2
  v_lshlrev_b32 v218, 3, v218
  v_add_u32 v218, 20480, v218
  v_mov_b32 v112, 0
  v_mov_b32 v113, 0
  v_mov_b32 v114, 0
  v_mov_b32 v115, 0
  v_mov_b32 v116, 0
  v_mov_b32 v117, 0
  v_mov_b32 v118, 0
  v_mov_b32 v119, 0
  v_mov_b32 v120, 0
  v_mov_b32 v121, 0
  v_mov_b32 v122, 0
  v_mov_b32 v123, 0
  v_mov_b32 v124, 0
  v_mov_b32 v125, 0
  v_mov_b32 v126, 0
  v_mov_b32 v127, 0
  v_mov_b32 v128, 0
  v_mov_b32 v129, 0
  v_mov_b32 v130, 0
  v_mov_b32 v131, 0
  v_mov_b32 v132, 0
  v_mov_b32 v133, 0
  v_mov_b32 v134, 0
  v_mov_b32 v135, 0
  v_mov_b32 v136, 0
  v_mov_b32 v137, 0
  v_mov_b32 v138, 0
  v_mov_b32 v139, 0
  v_mov_b32 v140, 0
  v_mov_b32 v141, 0
  v_mov_b32 v142, 0
  v_mov_b32 v143, 0
  v_mov_b32 v144, 0
  v_mov_b32 v145, 0
  v_mov_b32 v146, 0
  v_mov_b32 v147, 0
  v_mov_b32 v148, 0
  v_mov_b32 v149, 0
  v_mov_b32 v150, 0
  v_mov_b32 v151, 0
  v_mov_b32 v152, 0
  v_mov_b32 v153, 0
  v_mov_b32 v154, 0
  v_mov_b32 v155, 0
  v_mov_b32 v156, 0
  v_mov_b32 v157, 0
  v_mov_b32 v158, 0
  v_mov_b32 v159, 0
  v_mov_b32 v160, 0
  v_mov_b32 v161, 0
  v_mov_b32 v162, 0
  v_mov_b32 v163, 0
  v_mov_b32 v164, 0
  v_mov_b32 v165, 0
  v_mov_b32 v166, 0
  v_mov_b32 v167, 0
  v_mov_b32 v168, 0
  v_mov_b32 v169, 0
  v_mov_b32 v170, 0
  v_mov_b32 v171, 0
  v_mov_b32 v172, 0
  v_mov_b32 v173, 0
  v_mov_b32 v174, 0
  v_mov_b32 v175, 0
  v_mov_b32 v212, 0
  v_mov_b32 v213, 0
  v_mov_b32 v214, 0
  v_mov_b32 v215, 0
  v_accvgpr_write_b32 a60, 0
  v_accvgpr_write_b32 a61, 0
  v_accvgpr_write_b32 a62, 0
  v_accvgpr_write_b32 a63, 0
  s_waitcnt vmcnt(17)
  v_mfma_f32_32x32x16_bf16 v[176:191], a[0:3], v[16:19], 0
  s_waitcnt vmcnt(16)
  v_mfma_f32_32x32x16_bf16 v[176:191], a[4:7], v[20:23], v[176:191]
  s_waitcnt vmcnt(15)
  v_mfma_f32_32x32x16_bf16 v[192:207], a[0:3], v[24:27], 0
  s_waitcnt vmcnt(14)
  v_mfma_f32_32x32x16_bf16 v[192:207], a[4:7], v[28:31], v[192:207]
  s_nop 7
  v_max3_f32 v241, v176, v177, v178
  v_max3_f32 v241, v179, v180, v241
  v_max3_f32 v241, v181, v182, v241
  v_max3_f32 v241, v183, v184, v241
  v_max3_f32 v241, v185, v186, v241
  v_max3_f32 v241, v187, v188, v241
  v_max3_f32 v241, v189, v190, v241
  v_max_f32 v241, v191, v241
  s_waitcnt vmcnt(13)
  v_mfma_f32_32x32x16_bf16 v[176:191], a[0:3], v[32:35], 0
  s_waitcnt vmcnt(12)
  v_mfma_f32_32x32x16_bf16 v[176:191], a[4:7], v[36:39], v[176:191]
  v_max3_f32 v242, v192, v193, v194
  v_max3_f32 v242, v195, v196, v242
  v_max3_f32 v242, v197, v198, v242
  v_max3_f32 v242, v199, v200, v242
  v_max3_f32 v242, v201, v202, v242
  v_max3_f32 v242, v203, v204, v242
  v_max3_f32 v242, v205, v206, v242
  v_max_f32 v242, v207, v242
  s_waitcnt vmcnt(11)
  v_mfma_f32_32x32x16_bf16 v[192:207], a[0:3], v[40:43], 0
  s_waitcnt vmcnt(10)
  v_mfma_f32_32x32x16_bf16 v[192:207], a[4:7], v[44:47], v[192:207]
  v_max3_f32 v243, v176, v177, v178
  v_max3_f32 v243, v179, v180, v243
  v_max3_f32 v243, v181, v182, v243
  v_max3_f32 v243, v183, v184, v243
  v_max3_f32 v243, v185, v186, v243
  v_max3_f32 v243, v187, v188, v243
  v_max3_f32 v243, v189, v190, v243
  v_max_f32 v243, v191, v243
  s_nop 3
  v_max3_f32 v244, v192, v193, v194
  v_max3_f32 v244, v195, v196, v244
  v_max3_f32 v244, v197, v198, v244
  v_max3_f32 v244, v199, v200, v244
  v_max3_f32 v244, v201, v202, v244
  v_max3_f32 v244, v203, v204, v244
  v_max3_f32 v244, v205, v206, v244
  v_max_f32 v244, v207, v244
  s_cmp_eq_u32 s38, 0
  s_cbranch_scc1 L_att_nf_54
  s_add_u32 s39, s36, 4096
  s_mov_b32 s40, 1
L_att_fl_55:
  buffer_load_dwordx4 a[48:51], v1, s[8:11], s39 offen offset:0 sc1
  buffer_load_dwordx4 a[52:55], v1, s[8:11], s39 offen offset:1024 sc1
  s_waitcnt vmcnt(0)
  v_mfma_f32_32x32x16_bf16 v[176:191], a[48:51], v[16:19], 0
  v_mfma_f32_32x32x16_bf16 v[176:191], a[52:55], v[20:23], v[176:191]
  v_mfma_f32_32x32x16_bf16 v[192:207], a[48:51], v[24:27], 0
  v_mfma_f32_32x32x16_bf16 v[192:207], a[52:55], v[28:31], v[192:207]
  s_nop 9
  v_max3_f32 v241, v176, v177, v241
  v_max3_f32 v241, v178, v179, v241
  v_max3_f32 v241, v180, v181, v241
  v_max3_f32 v241, v182, v183, v241
  v_max3_f32 v241, v184, v185, v241
  v_max3_f32 v241, v186, v187, v241
  v_max3_f32 v241, v188, v189, v241
  v_max3_f32 v241, v190, v191, v241
  v_mfma_f32_32x32x16_bf16 v[176:191], a[48:51], v[32:35], 0
  v_mfma_f32_32x32x16_bf16 v[176:191], a[52:55], v[36:39], v[176:191]
  v_max3_f32 v242, v192, v193, v242
  v_max3_f32 v242, v194, v195, v242
  v_max3_f32 v242, v196, v197, v242
  v_max3_f32 v242, v198, v199, v242
  v_max3_f32 v242, v200, v201, v242
  v_max3_f32 v242, v202, v203, v242
  v_max3_f32 v242, v204, v205, v242
  v_max3_f32 v242, v206, v207, v242
  v_mfma_f32_32x32x16_bf16 v[192:207], a[48:51], v[40:43], 0
  v_mfma_f32_32x32x16_bf16 v[192:207], a[52:55], v[44:47], v[192:207]
  s_nop 1
  v_max3_f32 v243, v176, v177, v243
  v_max3_f32 v243, v178, v179, v243
  v_max3_f32 v243, v180, v181, v243
  v_max3_f32 v243, v182, v183, v243
  v_max3_f32 v243, v184, v185, v243
  v_max3_f32 v243, v186, v187, v243
  v_max3_f32 v243, v188, v189, v243
  v_max3_f32 v243, v190, v191, v243
  s_nop 1
  v_max3_f32 v244, v192, v193, v244
  v_max3_f32 v244, v194, v195, v244
  v_max3_f32 v244, v196, v197, v244
  v_max3_f32 v244, v198, v199, v244
  v_max3_f32 v244, v200, v201, v244
  v_max3_f32 v244, v202, v203, v244
  v_max3_f32 v244, v204, v205, v244
  v_max3_f32 v244, v206, v207, v244
  s_add_u32 s39, s39, 4096
  s_add_u32 s40, s40, 1
  s_cmp_lt_u32 s40, 16
  s_nop 7
  s_cbranch_scc1 L_att_fl_55
  v_accvgpr_write_b32 a60, 0
  v_accvgpr_write_b32 a61, 0
  v_accvgpr_write_b32 a62, 0
  v_accvgpr_write_b32 a63, 0
L_att_nf_54:
  v_mov_b32 v224, v241
  s_nop 1
  v_permlane32_swap_b32 v241, v224
  v_max_f32 v241, v241, v224
  v_sub_f32 v48, 0, v241
  v_mov_b32 v49, v48
  v_pk_mov_b32 v[50:51], v[48:49], v[48:49]
  v_pk_mov_b32 v[52:53], v[48:49], v[48:49]
  v_pk_mov_b32 v[54:55], v[48:49], v[48:49]
  v_pk_mov_b32 v[56:57], v[48:49], v[48:49]
  v_pk_mov_b32 v[58:59], v[48:49], v[48:49]
  v_pk_mov_b32 v[60:61], v[48:49], v[48:49]
  v_pk_mov_b32 v[62:63], v[48:49], v[48:49]
  s_nop 1
  v_mfma_f32_32x32x16_bf16 v[176:191], a[0:3], v[16:19], v[48:63]
  v_mfma_f32_32x32x16_bf16 v[176:191], a[4:7], v[20:23], v[176:191]
  v_mov_b32 v224, v242
  s_nop 1
  v_permlane32_swap_b32 v242, v224
  v_max_f32 v242, v242, v224
  v_sub_f32 v64, 0, v242
  v_mov_b32 v65, v64
  v_pk_mov_b32 v[66:67], v[64:65], v[64:65]
  v_pk_mov_b32 v[68:69], v[64:65], v[64:65]
  v_pk_mov_b32 v[70:71], v[64:65], v[64:65]
  v_pk_mov_b32 v[72:73], v[64:65], v[64:65]
  v_pk_mov_b32 v[74:75], v[64:65], v[64:65]
  v_pk_mov_b32 v[76:77], v[64:65], v[64:65]
  v_pk_mov_b32 v[78:79], v[64:65], v[64:65]
  v_mov_b32 v224, v243
  s_nop 1
  v_permlane32_swap_b32 v243, v224
  v_max_f32 v243, v243, v224
  v_sub_f32 v80, 0, v243
  v_mov_b32 v81, v80
  v_pk_mov_b32 v[82:83], v[80:81], v[80:81]
  v_pk_mov_b32 v[84:85], v[80:81], v[80:81]
  v_pk_mov_b32 v[86:87], v[80:81], v[80:81]
  v_pk_mov_b32 v[88:89], v[80:81], v[80:81]
  v_pk_mov_b32 v[90:91], v[80:81], v[80:81]
  v_pk_mov_b32 v[92:93], v[80:81], v[80:81]
  v_pk_mov_b32 v[94:95], v[80:81], v[80:81]
  v_mov_b32 v224, v244
  s_nop 1
  v_permlane32_swap_b32 v244, v224
  v_max_f32 v244, v244, v224
  v_sub_f32 v96, 0, v244
  v_mov_b32 v97, v96
  v_pk_mov_b32 v[98:99], v[96:97], v[96:97]
  v_pk_mov_b32 v[100:101], v[96:97], v[96:97]
  v_pk_mov_b32 v[102:103], v[96:97], v[96:97]
  v_pk_mov_b32 v[104:105], v[96:97], v[96:97]
  v_pk_mov_b32 v[106:107], v[96:97], v[96:97]
  v_pk_mov_b32 v[108:109], v[96:97], v[96:97]
  v_pk_mov_b32 v[110:111], v[96:97], v[96:97]
  v_exp_f32 v176, v176
  v_exp_f32 v177, v177
  v_mfma_f32_32x32x16_bf16 v[160:175], a[60:63], v[212:215], v[160:175]
  v_exp_f32 v178, v178
  v_exp_f32 v179, v179
  v_cvt_pk_bf16_f32 v208, v176, v177
  v_cvt_pk_bf16_f32 v209, v178, v179
  v_mfma_f32_32x32x16_bf16 v[192:207], a[0:3], v[24:27], v[64:79]
  v_exp_f32 v180, v180
  v_exp_f32 v181, v181
  v_exp_f32 v182, v182
  v_exp_f32 v183, v183
  v_cvt_pk_bf16_f32 v210, v180, v181
  v_cvt_pk_bf16_f32 v211, v182, v183
  v_mfma_f32_32x32x16_bf16 v[192:207], a[4:7], v[28:31], v[192:207]
  v_exp_f32 v184, v184
  v_exp_f32 v185, v185
  v_exp_f32 v186, v186
  v_exp_f32 v187, v187
  v_cvt_pk_bf16_f32 v212, v184, v185
  v_cvt_pk_bf16_f32 v213, v186, v187
  s_waitcnt vmcnt(9)
  v_mfma_f32_32x32x16_bf16 v[112:127], a[8:11], v[208:211], v[112:127]
  v_exp_f32 v188, v188
  v_exp_f32 v189, v189
  v_exp_f32 v190, v190
  v_exp_f32 v191, v191
  v_cvt_pk_bf16_f32 v214, v188, v189
  v_cvt_pk_bf16_f32 v215, v190, v191
  v_exp_f32 v192, v192
  v_exp_f32 v193, v193
  s_waitcnt vmcnt(8)
  v_mfma_f32_32x32x16_bf16 v[112:127], a[12:15], v[212:215], v[112:127]
  v_exp_f32 v194, v194
  v_exp_f32 v195, v195
  v_cvt_pk_bf16_f32 v208, v192, v193
  v_cvt_pk_bf16_f32 v209, v194, v195
  v_mfma_f32_32x32x16_bf16 v[176:191], a[0:3], v[32:35], v[80:95]
  buffer_load_dwordx4 a[48:51], v1, s[8:11], s37 offen offset:0 sc1
  buffer_load_dwordx4 a[52:55], v1, s[8:11], s37 offen offset:1024 sc1
  buffer_load_dwordx4 a[56:59], v1, s[8:11], s37 offen offset:2048 sc1
  buffer_load_dwordx4 a[60:63], v1, s[8:11], s37 offen offset:3072 sc1
  s_add_u32 s37, s37, 4096
  v_exp_f32 v196, v196
  v_exp_f32 v197, v197
  v_exp_f32 v198, v198
  v_exp_f32 v199, v199
  v_cvt_pk_bf16_f32 v210, v196, v197
  v_cvt_pk_bf16_f32 v211, v198, v199
  v_mfma_f32_32x32x16_bf16 v[176:191], a[4:7], v[36:39], v[176:191]
  v_exp_f32 v200, v200
  v_exp_f32 v201, v201
  v_exp_f32 v202, v202
  v_exp_f32 v203, v203
  v_cvt_pk_bf16_f32 v212, v200, v201
  v_cvt_pk_bf16_f32 v213, v202, v203
  v_mfma_f32_32x32x16_bf16 v[128:143], a[8:11], v[208:211], v[128:143]
  v_exp_f32 v204, v204
  v_exp_f32 v205, v205
  v_exp_f32 v206, v206
  v_exp_f32 v207, v207
  v_cvt_pk_bf16_f32 v214, v204, v205
  v_cvt_pk_bf16_f32 v215, v206, v207
  v_exp_f32 v176, v176
  v_exp_f32 v177, v177
  v_mfma_f32_32x32x16_bf16 v[128:143], a[12:15], v[212:215], v[128:143]
  v_exp_f32 v178, v178
  v_exp_f32 v179, v179
  v_cvt_pk_bf16_f32 v208, v176, v177
  v_cvt_pk_bf16_f32 v209, v178, v179
  v_mfma_f32_32x32x16_bf16 v[192:207], a[0:3], v[40:43], v[96:111]
  v_exp_f32 v180, v180
  v_exp_f32 v181, v181
  v_exp_f32 v182, v182
  v_exp_f32 v183, v183
  v_cvt_pk_bf16_f32 v210, v180, v181
  v_cvt_pk_bf16_f32 v211, v182, v183
  v_mfma_f32_32x32x16_bf16 v[192:207], a[4:7], v[44:47], v[192:207]
  v_exp_f32 v184, v184
  v_exp_f32 v185, v185
  v_exp_f32 v186, v186
  v_exp_f32 v187, v187
  v_cvt_pk_bf16_f32 v212, v184, v185
  v_cvt_pk_bf16_f32 v213, v186, v187
  v_mfma_f32_32x32x16_bf16 v[144:159], a[8:11], v[208:211], v[144:159]
  v_exp_f32 v188, v188
  v_exp_f32 v189, v189
  v_exp_f32 v190, v190
  v_exp_f32 v191, v191
  v_cvt_pk_bf16_f32 v214, v188, v189
  v_cvt_pk_bf16_f32 v215, v190, v191
  v_exp_f32 v192, v192
  v_exp_f32 v193, v193
  v_mfma_f32_32x32x16_bf16 v[144:159], a[12:15], v[212:215], v[144:159]
  v_exp_f32 v194, v194
  v_exp_f32 v195, v195
  v_cvt_pk_bf16_f32 v208, v192, v193
  v_cvt_pk_bf16_f32 v209, v194, v195
  s_waitcnt vmcnt(11)
  v_mfma_f32_32x32x16_bf16 v[176:191], a[16:19], v[16:19], v[48:63]
  v_exp_f32 v196, v196
  v_exp_f32 v197, v197
  v_exp_f32 v198, v198
  v_exp_f32 v199, v199
  v_cvt_pk_bf16_f32 v210, v196, v197
  v_cvt_pk_bf16_f32 v211, v198, v199
  s_waitcnt vmcnt(10)
  v_mfma_f32_32x32x16_bf16 v[176:191], a[20:23], v[20:23], v[176:191]
  v_exp_f32 v200, v200
  v_exp_f32 v201, v201
  v_exp_f32 v202, v202
  v_exp_f32 v203, v203
  v_cvt_pk_bf16_f32 v212, v200, v201
  v_cvt_pk_bf16_f32 v213, v202, v203
  v_mfma_f32_32x32x16_bf16 v[160:175], a[8:11], v[208:211], v[160:175]
  v_exp_f32 v204, v204
  v_exp_f32 v205, v205
  v_exp_f32 v206, v206
  v_exp_f32 v207, v207
  v_cvt_pk_bf16_f32 v214, v204, v205
  v_cvt_pk_bf16_f32 v215, v206, v207
  v_exp_f32 v176, v176
  v_exp_f32 v177, v177
  v_mfma_f32_32x32x16_bf16 v[160:175], a[12:15], v[212:215], v[160:175]
  v_exp_f32 v178, v178
  v_exp_f32 v179, v179
  v_cvt_pk_bf16_f32 v208, v176, v177
  v_cvt_pk_bf16_f32 v209, v178, v179
  v_mfma_f32_32x32x16_bf16 v[192:207], a[16:19], v[24:27], v[64:79]
  v_exp_f32 v180, v180
  v_exp_f32 v181, v181
  v_exp_f32 v182, v182
  v_exp_f32 v183, v183
  v_cvt_pk_bf16_f32 v210, v180, v181
  v_cvt_pk_bf16_f32 v211, v182, v183
  v_mfma_f32_32x32x16_bf16 v[192:207], a[20:23], v[28:31], v[192:207]
  v_exp_f32 v184, v184
  v_exp_f32 v185, v185
  v_exp_f32 v186, v186
  v_exp_f32 v187, v187
  v_cvt_pk_bf16_f32 v212, v184, v185
  v_cvt_pk_bf16_f32 v213, v186, v187
  s_waitcnt vmcnt(9)
  v_mfma_f32_32x32x16_bf16 v[112:127], a[24:27], v[208:211], v[112:127]
  v_exp_f32 v188, v188
  v_exp_f32 v189, v189
  v_exp_f32 v190, v190
  v_exp_f32 v191, v191
  v_cvt_pk_bf16_f32 v214, v188, v189
  v_cvt_pk_bf16_f32 v215, v190, v191
  v_exp_f32 v192, v192
  v_exp_f32 v193, v193
  s_waitcnt vmcnt(8)
  v_mfma_f32_32x32x16_bf16 v[112:127], a[28:31], v[212:215], v[112:127]
  v_exp_f32 v194, v194
  v_exp_f32 v195, v195
  v_cvt_pk_bf16_f32 v208, v192, v193
  v_cvt_pk_bf16_f32 v209, v194, v195
  v_mfma_f32_32x32x16_bf16 v[176:191], a[16:19], v[32:35], v[80:95]
  buffer_load_dwordx4 a[0:3], v1, s[8:11], s37 offen offset:0 sc1
  buffer_load_dwordx4 a[4:7], v1, s[8:11], s37 offen offset:1024 sc1
  buffer_load_dwordx4 a[8:11], v1, s[8:11], s37 offen offset:2048 sc1
  buffer_load_dwordx4 a[12:15], v1, s[8:11], s37 offen offset:3072 sc1
  s_add_u32 s37, s37, 4096
  v_exp_f32 v196, v196
  v_exp_f32 v197, v197
  v_exp_f32 v198, v198
  v_exp_f32 v199, v199
  v_cvt_pk_bf16_f32 v210, v196, v197
  v_cvt_pk_bf16_f32 v211, v198, v199
  v_mfma_f32_32x32x16_bf16 v[176:191], a[20:23], v[36:39], v[176:191]
  v_exp_f32 v200, v200
  v_exp_f32 v201, v201
  v_exp_f32 v202, v202
  v_exp_f32 v203, v203
  v_cvt_pk_bf16_f32 v212, v200, v201
  v_cvt_pk_bf16_f32 v213, v202, v203
  v_mfma_f32_32x32x16_bf16 v[128:143], a[24:27], v[208:211], v[128:143]
  v_exp_f32 v204, v204
  v_exp_f32 v205, v205
  v_exp_f32 v206, v206
  v_exp_f32 v207, v207
  v_cvt_pk_bf16_f32 v214, v204, v205
  v_cvt_pk_bf16_f32 v215, v206, v207
  v_exp_f32 v176, v176
  v_exp_f32 v177, v177
  v_mfma_f32_32x32x16_bf16 v[128:143], a[28:31], v[212:215], v[128:143]
  v_exp_f32 v178, v178
  v_exp_f32 v179, v179
  v_cvt_pk_bf16_f32 v208, v176, v177
  v_cvt_pk_bf16_f32 v209, v178, v179
  v_mfma_f32_32x32x16_bf16 v[192:207], a[16:19], v[40:43], v[96:111]
  v_exp_f32 v180, v180
  v_exp_f32 v181, v181
  v_exp_f32 v182, v182
  v_exp_f32 v183, v183
  v_cvt_pk_bf16_f32 v210, v180, v181
  v_cvt_pk_bf16_f32 v211, v182, v183
  v_mfma_f32_32x32x16_bf16 v[192:207], a[20:23], v[44:47], v[192:207]
  v_exp_f32 v184, v184
  v_exp_f32 v185, v185
  v_exp_f32 v186, v186
  v_exp_f32 v187, v187
  v_cvt_pk_bf16_f32 v212, v184, v185
  v_cvt_pk_bf16_f32 v213, v186, v187
  v_mfma_f32_32x32x16_bf16 v[144:159], a[24:27], v[208:211], v[144:159]
  v_exp_f32 v188, v188
  v_exp_f32 v189, v189
  v_exp_f32 v190, v190
  v_exp_f32 v191, v191
  v_cvt_pk_bf16_f32 v214, v188, v189
  v_cvt_pk_bf16_f32 v215, v190, v191
  v_exp_f32 v192, v192
  v_exp_f32 v193, v193
  v_mfma_f32_32x32x16_bf16 v[144:159], a[28:31], v[212:215], v[144:159]
  v_exp_f32 v194, v194
  v_exp_f32 v195, v195
  v_cvt_pk_bf16_f32 v208, v192, v193
  v_cvt_pk_bf16_f32 v209, v194, v195
  s_waitcnt vmcnt(11)
  v_mfma_f32_32x32x16_bf16 v[176:191], a[32:35], v[16:19], v[48:63]
  v_exp_f32 v196, v196
  v_exp_f32 v197, v197
  v_exp_f32 v198, v198
  v_exp_f32 v199, v199
  v_cvt_pk_bf16_f32 v210, v196, v197
  v_cvt_pk_bf16_f32 v211, v198, v199
  s_waitcnt vmcnt(10)
  v_mfma_f32_32x32x16_bf16 v[176:191], a[36:39], v[20:23], v[176:191]
  v_exp_f32 v200, v200
  v_exp_f32 v201, v201
  v_exp_f32 v202, v202
  v_exp_f32 v203, v203
  v_cvt_pk_bf16_f32 v212, v200, v201
  v_cvt_pk_bf16_f32 v213, v202, v203
  v_mfma_f32_32x32x16_bf16 v[160:175], a[24:27], v[208:211], v[160:175]
  v_exp_f32 v204, v204
  v_exp_f32 v205, v205
  v_exp_f32 v206, v206
  v_exp_f32 v207, v207
  v_cvt_pk_bf16_f32 v214, v204, v205
  v_cvt_pk_bf16_f32 v215, v206, v207
  v_exp_f32 v176, v176
  v_exp_f32 v177, v177
  v_mfma_f32_32x32x16_bf16 v[160:175], a[28:31], v[212:215], v[160:175]
  v_exp_f32 v178, v178
  v_exp_f32 v179, v179
  v_cvt_pk_bf16_f32 v208, v176, v177
  v_cvt_pk_bf16_f32 v209, v178, v179
  v_mfma_f32_32x32x16_bf16 v[192:207], a[32:35], v[24:27], v[64:79]
  v_exp_f32 v180, v180
  v_exp_f32 v181, v181
  v_exp_f32 v182, v182
  v_exp_f32 v183, v183
  v_cvt_pk_bf16_f32 v210, v180, v181
  v_cvt_pk_bf16_f32 v211, v182, v183
  v_mfma_f32_32x32x16_bf16 v[192:207], a[36:39], v[28:31], v[192:207]
  v_exp_f32 v184, v184
  v_exp_f32 v185, v185
  v_exp_f32 v186, v186
  v_exp_f32 v187, v187
  v_cvt_pk_bf16_f32 v212, v184, v185
  v_cvt_pk_bf16_f32 v213, v186, v187
  s_waitcnt vmcnt(9)
  v_mfma_f32_32x32x16_bf16 v[112:127], a[40:43], v[208:211], v[112:127]
  v_exp_f32 v188, v188
  v_exp_f32 v189, v189
  v_exp_f32 v190, v190
  v_exp_f32 v191, v191
  v_cvt_pk_bf16_f32 v214, v188, v189
  v_cvt_pk_bf16_f32 v215, v190, v191
  v_exp_f32 v192, v192
  v_exp_f32 v193, v193
  s_waitcnt vmcnt(8)
  v_mfma_f32_32x32x16_bf16 v[112:127], a[44:47], v[212:215], v[112:127]
  v_exp_f32 v194, v194
  v_exp_f32 v195, v195
  v_cvt_pk_bf16_f32 v208, v192, v193
  v_cvt_pk_bf16_f32 v209, v194, v195
  v_mfma_f32_32x32x16_bf16 v[176:191], a[32:35], v[32:35], v[80:95]
  buffer_load_dwordx4 a[16:19], v1, s[8:11], s37 offen offset:0 sc1
  buffer_load_dwordx4 a[20:23], v1, s[8:11], s37 offen offset:1024 sc1
  buffer_load_dwordx4 a[24:27], v1, s[8:11], s37 offen offset:2048 sc1
  buffer_load_dwordx4 a[28:31], v1, s[8:11], s37 offen offset:3072 sc1
  s_add_u32 s37, s37, 4096
  v_exp_f32 v196, v196
  v_exp_f32 v197, v197
  v_exp_f32 v198, v198
  v_exp_f32 v199, v199
  v_cvt_pk_bf16_f32 v210, v196, v197
  v_cvt_pk_bf16_f32 v211, v198, v199
  v_mfma_f32_32x32x16_bf16 v[176:191], a[36:39], v[36:39], v[176:191]
  v_exp_f32 v200, v200
  v_exp_f32 v201, v201
  v_exp_f32 v202, v202
  v_exp_f32 v203, v203
  v_cvt_pk_bf16_f32 v212, v200, v201
  v_cvt_pk_bf16_f32 v213, v202, v203
  v_mfma_f32_32x32x16_bf16 v[128:143], a[40:43], v[208:211], v[128:143]
  v_exp_f32 v204, v204
  v_exp_f32 v205, v205
  v_exp_f32 v206, v206
  v_exp_f32 v207, v207
  v_cvt_pk_bf16_f32 v214, v204, v205
  v_cvt_pk_bf16_f32 v215, v206, v207
  v_exp_f32 v176, v176
  v_exp_f32 v177, v177
  v_mfma_f32_32x32x16_bf16 v[128:143], a[44:47], v[212:215], v[128:143]
  v_exp_f32 v178, v178
  v_exp_f32 v179, v179
  v_cvt_pk_bf16_f32 v208, v176, v177
  v_cvt_pk_bf16_f32 v209, v178, v179
  v_mfma_f32_32x32x16_bf16 v[192:207], a[32:35], v[40:43], v[96:111]
  v_exp_f32 v180, v180
  v_exp_f32 v181, v181
  v_exp_f32 v182, v182
  v_exp_f32 v183, v183
  v_cvt_pk_bf16_f32 v210, v180, v181
  v_cvt_pk_bf16_f32 v211, v182, v183
  v_mfma_f32_32x32x16_bf16 v[192:207], a[36:39], v[44:47], v[192:207]
  v_exp_f32 v184, v184
  v_exp_f32 v185, v185
  v_exp_f32 v186, v186
  v_exp_f32 v187, v187
  v_cvt_pk_bf16_f32 v212, v184, v185
  v_cvt_pk_bf16_f32 v213, v186, v187
  v_mfma_f32_32x32x16_bf16 v[144:159], a[40:43], v[208:211], v[144:159]
  v_exp_f32 v188, v188
  v_exp_f32 v189, v189
  v_exp_f32 v190, v190
  v_exp_f32 v191, v191
  v_cvt_pk_bf16_f32 v214, v188, v189
  v_cvt_pk_bf16_f32 v215, v190, v191
  v_exp_f32 v192, v192
  v_exp_f32 v193, v193
  v_mfma_f32_32x32x16_bf16 v[144:159], a[44:47], v[212:215], v[144:159]
  v_exp_f32 v194, v194
  v_exp_f32 v195, v195
  v_cvt_pk_bf16_f32 v208, v192, v193
  v_cvt_pk_bf16_f32 v209, v194, v195
  s_waitcnt vmcnt(11)
  v_mfma_f32_32x32x16_bf16 v[176:191], a[48:51], v[16:19], v[48:63]
  v_exp_f32 v196, v196
  v_exp_f32 v197, v197
  v_exp_f32 v198, v198
  v_exp_f32 v199, v199
  v_cvt_pk_bf16_f32 v210, v196, v197
  v_cvt_pk_bf16_f32 v211, v198, v199
  s_waitcnt vmcnt(10)
  v_mfma_f32_32x32x16_bf16 v[176:191], a[52:55], v[20:23], v[176:191]
  v_exp_f32 v200, v200
  v_exp_f32 v201, v201
  v_exp_f32 v202, v202
  v_exp_f32 v203, v203
  v_cvt_pk_bf16_f32 v212, v200, v201
  v_cvt_pk_bf16_f32 v213, v202, v203
  v_mfma_f32_32x32x16_bf16 v[160:175], a[40:43], v[208:211], v[160:175]
  v_exp_f32 v204, v204
  v_exp_f32 v205, v205
  v_exp_f32 v206, v206
  v_exp_f32 v207, v207
  v_cvt_pk_bf16_f32 v214, v204, v205
  v_cvt_pk_bf16_f32 v215, v206, v207
  v_exp_f32 v176, v176
  v_exp_f32 v177, v177
  v_mfma_f32_32x32x16_bf16 v[160:175], a[44:47], v[212:215], v[160:175]
  v_exp_f32 v178, v178
  v_exp_f32 v179, v179
  v_cvt_pk_bf16_f32 v208, v176, v177
  v_cvt_pk_bf16_f32 v209, v178, v179
  v_mfma_f32_32x32x16_bf16 v[192:207], a[48:51], v[24:27], v[64:79]
  v_exp_f32 v180, v180
  v_exp_f32 v181, v181
  v_exp_f32 v182, v182
  v_exp_f32 v183, v183
  v_cvt_pk_bf16_f32 v210, v180, v181
  v_cvt_pk_bf16_f32 v211, v182, v183
  v_mfma_f32_32x32x16_bf16 v[192:207], a[52:55], v[28:31], v[192:207]
  v_exp_f32 v184, v184
  v_exp_f32 v185, v185
  v_exp_f32 v186, v186
  v_exp_f32 v187, v187
  v_cvt_pk_bf16_f32 v212, v184, v185
  v_cvt_pk_bf16_f32 v213, v186, v187
  s_waitcnt vmcnt(9)
  v_mfma_f32_32x32x16_bf16 v[112:127], a[56:59], v[208:211], v[112:127]
  v_exp_f32 v188, v188
  v_exp_f32 v189, v189
  v_exp_f32 v190, v190
  v_exp_f32 v191, v191
  v_cvt_pk_bf16_f32 v214, v188, v189
  v_cvt_pk_bf16_f32 v215, v190, v191
  v_exp_f32 v192, v192
  v_exp_f32 v193, v193
  s_waitcnt vmcnt(8)
  v_mfma_f32_32x32x16_bf16 v[112:127], a[60:63], v[212:215], v[112:127]
  v_exp_f32 v194, v194
  v_exp_f32 v195, v195
  v_cvt_pk_bf16_f32 v208, v192, v193
  v_cvt_pk_bf16_f32 v209, v194, v195
  v_mfma_f32_32x32x16_bf16 v[176:191], a[48:51], v[32:35], v[80:95]
  buffer_load_dwordx4 a[32:35], v1, s[8:11], s37 offen offset:0 sc1
  buffer_load_dwordx4 a[36:39], v1, s[8:11], s37 offen offset:1024 sc1
  buffer_load_dwordx4 a[40:43], v1, s[8:11], s37 offen offset:2048 sc1
  buffer_load_dwordx4 a[44:47], v1, s[8:11], s37 offen offset:3072 sc1
  s_add_u32 s37, s37, 4096
  v_exp_f32 v196, v196
  v_exp_f32 v197, v197
  v_exp_f32 v198, v198
  v_exp_f32 v199, v199
  v_cvt_pk_bf16_f32 v210, v196, v197
  v_cvt_pk_bf16_f32 v211, v198, v199
  v_mfma_f32_32x32x16_bf16 v[176:191], a[52:55], v[36:39], v[176:191]
  v_exp_f32 v200, v200
  v_exp_f32 v201, v201
  v_exp_f32 v202, v202
  v_exp_f32 v203, v203
  v_cvt_pk_bf16_f32 v212, v200, v201
  v_cvt_pk_bf16_f32 v213, v202, v203
  v_mfma_f32_32x32x16_bf16 v[128:143], a[56:59], v[208:211], v[128:143]
  v_exp_f32 v204, v204
  v_exp_f32 v205, v205
  v_exp_f32 v206, v206
  v_exp_f32 v207, v207
  v_cvt_pk_bf16_f32 v214, v204, v205
  v_cvt_pk_bf16_f32 v215, v206, v207
  v_exp_f32 v176, v176
  v_exp_f32 v177, v177
  v_mfma_f32_32x32x16_bf16 v[128:143], a[60:63], v[212:215], v[128:143]
  v_exp_f32 v178, v178
  v_exp_f32 v179, v179
  v_cvt_pk_bf16_f32 v208, v176, v177
  v_cvt_pk_bf16_f32 v209, v178, v179
  v_mfma_f32_32x32x16_bf16 v[192:207], a[48:51], v[40:43], v[96:111]
  v_exp_f32 v180, v180
  v_exp_f32 v181, v181
  v_exp_f32 v182, v182
  v_exp_f32 v183, v183
  v_cvt_pk_bf16_f32 v210, v180, v181
  v_cvt_pk_bf16_f32 v211, v182, v183
  v_mfma_f32_32x32x16_bf16 v[192:207], a[52:55], v[44:47], v[192:207]
  v_exp_f32 v184, v184
  v_exp_f32 v185, v185
  v_exp_f32 v186, v186
  v_exp_f32 v187, v187
  v_cvt_pk_bf16_f32 v212, v184, v185
  v_cvt_pk_bf16_f32 v213, v186, v187
  v_mfma_f32_32x32x16_bf16 v[144:159], a[56:59], v[208:211], v[144:159]
  v_exp_f32 v188, v188
  v_exp_f32 v189, v189
  v_exp_f32 v190, v190
  v_exp_f32 v191, v191
  v_cvt_pk_bf16_f32 v214, v188, v189
  v_cvt_pk_bf16_f32 v215, v190, v191
  v_exp_f32 v192, v192
  v_exp_f32 v193, v193
  v_mfma_f32_32x32x16_bf16 v[144:159], a[60:63], v[212:215], v[144:159]
  v_exp_f32 v194, v194
  v_exp_f32 v195, v195
  v_cvt_pk_bf16_f32 v208, v192, v193
  v_cvt_pk_bf16_f32 v209, v194, v195
  s_waitcnt vmcnt(11)
  v_mfma_f32_32x32x16_bf16 v[176:191], a[0:3], v[16:19], v[48:63]
  v_exp_f32 v196, v196
  v_exp_f32 v197, v197
  v_exp_f32 v198, v198
  v_exp_f32 v199, v199
  v_cvt_pk_bf16_f32 v210, v196, v197
  v_cvt_pk_bf16_f32 v211, v198, v199
  s_waitcnt vmcnt(10)
  v_mfma_f32_32x32x16_bf16 v[176:191], a[4:7], v[20:23], v[176:191]
  v_exp_f32 v200, v200
  v_exp_f32 v201, v201
  v_exp_f32 v202, v202
  v_exp_f32 v203, v203
  v_cvt_pk_bf16_f32 v212, v200, v201
  v_cvt_pk_bf16_f32 v213, v202, v203
  v_mfma_f32_32x32x16_bf16 v[160:175], a[56:59], v[208:211], v[160:175]
  v_exp_f32 v204, v204
  v_exp_f32 v205, v205
  v_exp_f32 v206, v206
  v_exp_f32 v207, v207
  v_cvt_pk_bf16_f32 v214, v204, v205
  v_cvt_pk_bf16_f32 v215, v206, v207
  v_exp_f32 v176, v176
  v_exp_f32 v177, v177
  v_mfma_f32_32x32x16_bf16 v[160:175], a[60:63], v[212:215], v[160:175]
  v_exp_f32 v178, v178
  v_exp_f32 v179, v179
  v_cvt_pk_bf16_f32 v208, v176, v177
  v_cvt_pk_bf16_f32 v209, v178, v179
  v_mfma_f32_32x32x16_bf16 v[192:207], a[0:3], v[24:27], v[64:79]
  buffer_load_dwordx2 v[216:217], v218, s[8:11], 0 offen sc1
  v_exp_f32 v180, v180
  v_exp_f32 v181, v181
  v_exp_f32 v182, v182
  v_exp_f32 v183, v183
  v_cvt_pk_bf16_f32 v210, v180, v181
  v_cvt_pk_bf16_f32 v211, v182, v183
  v_mfma_f32_32x32x16_bf16 v[192:207], a[4:7], v[28:31], v[192:207]
  v_exp_f32 v184, v184
  v_exp_f32 v185, v185
  v_exp_f32 v186, v186
  v_exp_f32 v187, v187
  v_cvt_pk_bf16_f32 v212, v184, v185
  v_cvt_pk_bf16_f32 v213, v186, v187
  s_waitcnt vmcnt(10)
  v_mfma_f32_32x32x16_bf16 v[112:127], a[8:11], v[208:211], v[112:127]
  v_exp_f32 v188, v188
  v_exp_f32 v189, v189
  v_exp_f32 v190, v190
  v_exp_f32 v191, v191
  v_cvt_pk_bf16_f32 v214, v188, v189
  v_cvt_pk_bf16_f32 v215, v190, v191
  v_exp_f32 v192, v192
  v_exp_f32 v193, v193
  s_waitcnt vmcnt(9)
  v_mfma_f32_32x32x16_bf16 v[112:127], a[12:15], v[212:215], v[112:127]
  v_exp_f32 v194, v194
  v_exp_f32 v195, v195
  v_cvt_pk_bf16_f32 v208, v192, v193
  v_cvt_pk_bf16_f32 v209, v194, v195
  v_mfma_f32_32x32x16_bf16 v[176:191], a[0:3], v[32:35], v[80:95]
  buffer_load_dwordx4 a[48:51], v1, s[8:11], s37 offen offset:0 sc1
  buffer_load_dwordx4 a[52:55], v1, s[8:11], s37 offen offset:1024 sc1
  buffer_load_dwordx4 a[56:59], v1, s[8:11], s37 offen offset:2048 sc1
  buffer_load_dwordx4 a[60:63], v1, s[8:11], s37 offen offset:3072 sc1
  s_add_u32 s37, s37, 4096
  v_exp_f32 v196, v196
  v_exp_f32 v197, v197
  v_exp_f32 v198, v198
  v_exp_f32 v199, v199
  v_cvt_pk_bf16_f32 v210, v196, v197
  v_cvt_pk_bf16_f32 v211, v198, v199
  v_mfma_f32_32x32x16_bf16 v[176:191], a[4:7], v[36:39], v[176:191]
  v_exp_f32 v200, v200
  v_exp_f32 v201, v201
  v_exp_f32 v202, v202
  v_exp_f32 v203, v203
  v_cvt_pk_bf16_f32 v212, v200, v201
  v_cvt_pk_bf16_f32 v213, v202, v203
  v_mfma_f32_32x32x16_bf16 v[128:143], a[8:11], v[208:211], v[128:143]
  v_exp_f32 v204, v204
  v_exp_f32 v205, v205
  v_exp_f32 v206, v206
  v_exp_f32 v207, v207
  v_cvt_pk_bf16_f32 v214, v204, v205
  v_cvt_pk_bf16_f32 v215, v206, v207
  v_exp_f32 v176, v176
  v_exp_f32 v177, v177
  v_mfma_f32_32x32x16_bf16 v[128:143], a[12:15], v[212:215], v[128:143]
  v_exp_f32 v178, v178
  v_exp_f32 v179, v179
  v_cvt_pk_bf16_f32 v208, v176, v177
  v_cvt_pk_bf16_f32 v209, v178, v179
  v_mfma_f32_32x32x16_bf16 v[192:207], a[0:3], v[40:43], v[96:111]
  v_exp_f32 v180, v180
  v_exp_f32 v181, v181
  v_exp_f32 v182, v182
  v_exp_f32 v183, v183
  v_cvt_pk_bf16_f32 v210, v180, v181
  v_cvt_pk_bf16_f32 v211, v182, v183
  v_mfma_f32_32x32x16_bf16 v[192:207], a[4:7], v[44:47], v[192:207]
  v_exp_f32 v184, v184
  v_exp_f32 v185, v185
  v_exp_f32 v186, v186
  v_exp_f32 v187, v187
  v_cvt_pk_bf16_f32 v212, v184, v185
  v_cvt_pk_bf16_f32 v213, v186, v187
  v_mfma_f32_32x32x16_bf16 v[144:159], a[8:11], v[208:211], v[144:159]
  v_exp_f32 v188, v188
  v_exp_f32 v189, v189
  v_exp_f32 v190, v190
  v_exp_f32 v191, v191
  v_cvt_pk_bf16_f32 v214, v188, v189
  v_cvt_pk_bf16_f32 v215, v190, v191
  v_exp_f32 v192, v192
  v_exp_f32 v193, v193
  v_mfma_f32_32x32x16_bf16 v[144:159], a[12:15], v[212:215], v[144:159]
  v_exp_f32 v194, v194
  v_exp_f32 v195, v195
  v_cvt_pk_bf16_f32 v208, v192, v193
  v_cvt_pk_bf16_f32 v209, v194, v195
  s_waitcnt vmcnt(12)
  v_mfma_f32_32x32x16_bf16 v[176:191], a[16:19], v[16:19], v[48:63]
  v_exp_f32 v196, v196
  v_exp_f32 v197, v197
  v_exp_f32 v198, v198
  v_exp_f32 v199, v199
  v_cvt_pk_bf16_f32 v210, v196, v197
  v_cvt_pk_bf16_f32 v211, v198, v199
  s_waitcnt vmcnt(11)
  v_mfma_f32_32x32x16_bf16 v[176:191], a[20:23], v[20:23], v[176:191]
  v_exp_f32 v200, v200
  v_exp_f32 v201, v201
  v_exp_f32 v202, v202
  v_exp_f32 v203, v203
  v_cvt_pk_bf16_f32 v212, v200, v201
  v_cvt_pk_bf16_f32 v213, v202, v203
  v_mfma_f32_32x32x16_bf16 v[160:175], a[8:11], v[208:211], v[160:175]
  v_exp_f32 v204, v204
  v_exp_f32 v205, v205
  v_exp_f32 v206, v206
  v_exp_f32 v207, v207
  v_cvt_pk_bf16_f32 v214, v204, v205
  v_cvt_pk_bf16_f32 v215, v206, v207
  v_exp_f32 v176, v176
  v_exp_f32 v177, v177
  v_mfma_f32_32x32x16_bf16 v[160:175], a[12:15], v[212:215], v[160:175]
  v_exp_f32 v178, v178
  v_exp_f32 v179, v179
  v_cvt_pk_bf16_f32 v208, v176, v177
  v_cvt_pk_bf16_f32 v209, v178, v179
  v_mfma_f32_32x32x16_bf16 v[192:207], a[16:19], v[24:27], v[64:79]
  s_waitcnt vmcnt(4)
  v_and_b32 v216, v216, v217
  v_cmp_eq_u32 vcc, 1, v216
  s_nop 0
  s_cmp_eq_u64 vcc, -1
  s_cbranch_scc1 L_pc_56
  s_cmp_lg_u32 s60, 0
  s_cbranch_scc1 L_pc_56
  s_mov_b32 s58, 0
L_pcl_57:
  buffer_load_dwordx2 v[216:217], v218, s[8:11], 0 offen sc1
  s_waitcnt vmcnt(0)
  v_and_b32 v216, v216, v217
  v_cmp_eq_u32 vcc, 1, v216
  s_add_u32 s58, s58, 1
  s_cmp_eq_u64 vcc, -1
  s_cbranch_scc1 L_pc_56
  s_cmp_lt_u32 s58, 60000
  s_cbranch_scc1 L_pcl_57
  s_or_b32 s60, s60, 1
L_pc_56:
  v_exp_f32 v180, v180
  v_exp_f32 v181, v181
  v_exp_f32 v182, v182
  v_exp_f32 v183, v183
  v_cvt_pk_bf16_f32 v210, v180, v181
  v_cvt_pk_bf16_f32 v211, v182, v183
  v_mfma_f32_32x32x16_bf16 v[192:207], a[20:23], v[28:31], v[192:207]
  v_exp_f32 v184, v184
  v_exp_f32 v185, v185
  v_exp_f32 v186, v186
  v_exp_f32 v187, v187
  v_cvt_pk_bf16_f32 v212, v184, v185
  v_cvt_pk_bf16_f32 v213, v186, v187
  v_mfma_f32_32x32x16_bf16 v[112:127], a[24:27], v[208:211], v[112:127]
  v_exp_f32 v188, v188
  v_exp_f32 v189, v189
  v_exp_f32 v190, v190
  v_exp_f32 v191, v191
  v_cvt_pk_bf16_f32 v214, v188, v189
  v_cvt_pk_bf16_f32 v215, v190, v191
  v_exp_f32 v192, v192
  v_exp_f32 v193, v193
  v_mfma_f32_32x32x16_bf16 v[112:127], a[28:31], v[212:215], v[112:127]
  v_exp_f32 v194, v194
  v_exp_f32 v195, v195
  v_cvt_pk_bf16_f32 v208, v192, v193
  v_cvt_pk_bf16_f32 v209, v194, v195
  v_mfma_f32_32x32x16_bf16 v[176:191], a[16:19], v[32:35], v[80:95]
  buffer_load_dwordx4 a[0:3], v1, s[8:11], s37 offen offset:0 sc1
  buffer_load_dwordx4 a[4:7], v1, s[8:11], s37 offen offset:1024 sc1
  buffer_load_dwordx4 a[8:11], v1, s[8:11], s37 offen offset:2048 sc1
  buffer_load_dwordx4 a[12:15], v1, s[8:11], s37 offen offset:3072 sc1
  s_add_u32 s37, s37, 4096
  v_exp_f32 v196, v196
  v_exp_f32 v197, v197
  v_exp_f32 v198, v198
  v_exp_f32 v199, v199
  v_cvt_pk_bf16_f32 v210, v196, v197
  v_cvt_pk_bf16_f32 v211, v198, v199
  v_mfma_f32_32x32x16_bf16 v[176:191], a[20:23], v[36:39], v[176:191]
  v_exp_f32 v200, v200
  v_exp_f32 v201, v201
  v_exp_f32 v202, v202
  v_exp_f32 v203, v203
  v_cvt_pk_bf16_f32 v212, v200, v201
  v_cvt_pk_bf16_f32 v213, v202, v203
  v_mfma_f32_32x32x16_bf16 v[128:143], a[24:27], v[208:211], v[128:143]
  v_exp_f32 v204, v204
  v_exp_f32 v205, v205
  v_exp_f32 v206, v206
  v_exp_f32 v207, v207
  v_cvt_pk_bf16_f32 v214, v204, v205
  v_cvt_pk_bf16_f32 v215, v206, v207
  v_exp_f32 v176, v176
  v_exp_f32 v177, v177
  v_mfma_f32_32x32x16_bf16 v[128:143], a[28:31], v[212:215], v[128:143]
  v_exp_f32 v178, v178
  v_exp_f32 v179, v179
  v_cvt_pk_bf16_f32 v208, v176, v177
  v_cvt_pk_bf16_f32 v209, v178, v179
  v_mfma_f32_32x32x16_bf16 v[192:207], a[16:19], v[40:43], v[96:111]
  s_and_b32 s98, s3, 1
  s_xor_b32 s98, s98, 0
  s_lshl_b32 s99, s81, 1
  s_add_u32 s98, s98, s99
  s_mul_i32 s98, s98, 32
  s_mul_i32 s99, s3, 8
  s_add_u32 s98, s98, s99
  s_lshl_b32 s98, s98, 10
  s_add_u32 s96, s98, 1490944
  buffer_load_dwordx4 a[64:67], v1, s[8:11], s96 offen offset:0 sc1
  buffer_load_dwordx4 a[68:71], v1, s[8:11], s96 offen offset:1024 sc1
  buffer_load_dwordx4 a[72:75], v1, s[8:11], s96 offen offset:2048 sc1
  buffer_load_dwordx4 a[76:79], v1, s[8:11], s96 offen offset:3072 sc1
  v_exp_f32 v180, v180
  v_exp_f32 v181, v181
  v_exp_f32 v182, v182
  v_exp_f32 v183, v183
  v_cvt_pk_bf16_f32 v210, v180, v181
  v_cvt_pk_bf16_f32 v211, v182, v183
  v_mfma_f32_32x32x16_bf16 v[192:207], a[20:23], v[44:47], v[192:207]
  v_exp_f32 v184, v184
  v_exp_f32 v185, v185
  v_exp_f32 v186, v186
  v_exp_f32 v187, v187
  v_cvt_pk_bf16_f32 v212, v184, v185
  v_cvt_pk_bf16_f32 v213, v186, v187
  v_mfma_f32_32x32x16_bf16 v[144:159], a[24:27], v[208:211], v[144:159]
  v_exp_f32 v188, v188
  v_exp_f32 v189, v189
  v_exp_f32 v190, v190
  v_exp_f32 v191, v191
  v_cvt_pk_bf16_f32 v214, v188, v189
  v_cvt_pk_bf16_f32 v215, v190, v191
  v_exp_f32 v192, v192
  v_exp_f32 v193, v193
  v_mfma_f32_32x32x16_bf16 v[144:159], a[28:31], v[212:215], v[144:159]
  v_exp_f32 v194, v194
  v_exp_f32 v195, v195
  v_cvt_pk_bf16_f32 v208, v192, v193
  v_cvt_pk_bf16_f32 v209, v194, v195
  v_mfma_f32_32x32x16_bf16 v[176:191], a[32:35], v[16:19], v[48:63]
  s_add_u32 s96, s96, 4096
  buffer_load_dwordx4 a[80:83], v1, s[8:11], s96 offen offset:0 sc1
  v_exp_f32 v196, v196
  v_exp_f32 v197, v197
  v_exp_f32 v198, v198
  v_exp_f32 v199, v199
  v_cvt_pk_bf16_f32 v210, v196, v197
  v_cvt_pk_bf16_f32 v211, v198, v199
  v_mfma_f32_32x32x16_bf16 v[176:191], a[36:39], v[20:23], v[176:191]
  v_exp_f32 v200, v200
  v_exp_f32 v201, v201
  v_exp_f32 v202, v202
  v_exp_f32 v203, v203
  v_cvt_pk_bf16_f32 v212, v200, v201
  v_cvt_pk_bf16_f32 v213, v202, v203
  v_mfma_f32_32x32x16_bf16 v[160:175], a[24:27], v[208:211], v[160:175]
  v_exp_f32 v204, v204
  v_exp_f32 v205, v205
  v_exp_f32 v206, v206
  v_exp_f32 v207, v207
  v_cvt_pk_bf16_f32 v214, v204, v205
  v_cvt_pk_bf16_f32 v215, v206, v207
  v_exp_f32 v176, v176
  v_exp_f32 v177, v177
  v_mfma_f32_32x32x16_bf16 v[160:175], a[28:31], v[212:215], v[160:175]
  v_exp_f32 v178, v178
  v_exp_f32 v179, v179
  v_cvt_pk_bf16_f32 v208, v176, v177
  v_cvt_pk_bf16_f32 v209, v178, v179
  v_mfma_f32_32x32x16_bf16 v[192:207], a[32:35], v[24:27], v[64:79]
  buffer_load_dwordx4 a[84:87], v1, s[8:11], s96 offen offset:1024 sc1
  buffer_load_dwordx4 a[88:91], v1, s[8:11], s96 offen offset:2048 sc1
  v_exp_f32 v180, v180
  v_exp_f32 v181, v181
  v_exp_f32 v182, v182
  v_exp_f32 v183, v183
  v_cvt_pk_bf16_f32 v210, v180, v181
  v_cvt_pk_bf16_f32 v211, v182, v183
  v_mfma_f32_32x32x16_bf16 v[192:207], a[36:39], v[28:31], v[192:207]
  v_exp_f32 v184, v184
  v_exp_f32 v185, v185
  v_exp_f32 v186, v186
  v_exp_f32 v187, v187
  v_cvt_pk_bf16_f32 v212, v184, v185
  v_cvt_pk_bf16_f32 v213, v186, v187
  v_mfma_f32_32x32x16_bf16 v[112:127], a[40:43], v[208:211], v[112:127]
  v_exp_f32 v188, v188
  v_exp_f32 v189, v189
  v_exp_f32 v190, v190
  v_exp_f32 v191, v191
  v_cvt_pk_bf16_f32 v214, v188, v189
  v_cvt_pk_bf16_f32 v215, v190, v191
  v_exp_f32 v192, v192
  v_exp_f32 v193, v193
  v_mfma_f32_32x32x16_bf16 v[112:127], a[44:47], v[212:215], v[112:127]
  v_exp_f32 v194, v194
  v_exp_f32 v195, v195
  v_cvt_pk_bf16_f32 v208, v192, v193
  v_cvt_pk_bf16_f32 v209, v194, v195
  v_mfma_f32_32x32x16_bf16 v[176:191], a[32:35], v[32:35], v[80:95]
  buffer_load_dwordx4 a[16:19], v1, s[8:11], s37 offen offset:0 sc1
  buffer_load_dwordx4 a[20:23], v1, s[8:11], s37 offen offset:1024 sc1
  buffer_load_dwordx4 a[24:27], v1, s[8:11], s37 offen offset:2048 sc1
  buffer_load_dwordx4 a[28:31], v1, s[8:11], s37 offen offset:3072 sc1
  s_add_u32 s37, s37, 4096
  v_exp_f32 v196, v196
  v_exp_f32 v197, v197
  v_exp_f32 v198, v198
  v_exp_f32 v199, v199
  v_cvt_pk_bf16_f32 v210, v196, v197
  v_cvt_pk_bf16_f32 v211, v198, v199
  v_mfma_f32_32x32x16_bf16 v[176:191], a[36:39], v[36:39], v[176:191]
  v_exp_f32 v200, v200
  v_exp_f32 v201, v201
  v_exp_f32 v202, v202
  v_exp_f32 v203, v203
  v_cvt_pk_bf16_f32 v212, v200, v201
  v_cvt_pk_bf16_f32 v213, v202, v203
  v_mfma_f32_32x32x16_bf16 v[128:143], a[40:43], v[208:211], v[128:143]
  v_exp_f32 v204, v204
  v_exp_f32 v205, v205
  v_exp_f32 v206, v206
  v_exp_f32 v207, v207
  v_cvt_pk_bf16_f32 v214, v204, v205
  v_cvt_pk_bf16_f32 v215, v206, v207
  v_exp_f32 v176, v176
  v_exp_f32 v177, v177
  v_mfma_f32_32x32x16_bf16 v[128:143], a[44:47], v[212:215], v[128:143]
  v_exp_f32 v178, v178
  v_exp_f32 v179, v179
  v_cvt_pk_bf16_f32 v208, v176, v177
  v_cvt_pk_bf16_f32 v209, v178, v179
  v_mfma_f32_32x32x16_bf16 v[192:207], a[32:35], v[40:43], v[96:111]
  buffer_load_dwordx4 a[92:95], v1, s[8:11], s96 offen offset:3072 sc1
  s_and_b32 s98, s3, 1
  s_xor_b32 s98, s98, 1
  s_lshl_b32 s99, s81, 1
  s_add_u32 s98, s98, s99
  s_mul_i32 s98, s98, 32
  s_mul_i32 s99, s3, 8
  s_add_u32 s98, s98, s99
  s_lshl_b32 s98, s98, 10
  s_add_u32 s96, s98, 1490944
  buffer_load_dwordx4 a[96:99], v1, s[8:11], s96 offen offset:0 sc1
  buffer_load_dwordx4 a[100:103], v1, s[8:11], s96 offen offset:1024 sc1
  v_exp_f32 v180, v180
  v_exp_f32 v181, v181
  v_exp_f32 v182, v182
  v_exp_f32 v183, v183
  v_cvt_pk_bf16_f32 v210, v180, v181
  v_cvt_pk_bf16_f32 v211, v182, v183
  v_mfma_f32_32x32x16_bf16 v[192:207], a[36:39], v[44:47], v[192:207]
  v_exp_f32 v184, v184
  v_exp_f32 v185, v185
  v_exp_f32 v186, v186
  v_exp_f32 v187, v187
  v_cvt_pk_bf16_f32 v212, v184, v185
  v_cvt_pk_bf16_f32 v213, v186, v187
  v_mfma_f32_32x32x16_bf16 v[144:159], a[40:43], v[208:211], v[144:159]
  v_exp_f32 v188, v188
  v_exp_f32 v189, v189
  v_exp_f32 v190, v190
  v_exp_f32 v191, v191
  v_cvt_pk_bf16_f32 v214, v188, v189
  v_cvt_pk_bf16_f32 v215, v190, v191
  v_exp_f32 v192, v192
  v_exp_f32 v193, v193
  v_mfma_f32_32x32x16_bf16 v[144:159], a[44:47], v[212:215], v[144:159]
  v_exp_f32 v194, v194
  v_exp_f32 v195, v195
  v_cvt_pk_bf16_f32 v208, v192, v193
  v_cvt_pk_bf16_f32 v209, v194, v195
  s_waitcnt vmcnt(21)
  v_mfma_f32_32x32x16_bf16 v[176:191], a[48:51], v[16:19], v[48:63]
  buffer_load_dwordx4 a[104:107], v1, s[8:11], s96 offen offset:2048 sc1
  buffer_load_dwordx4 a[108:111], v1, s[8:11], s96 offen offset:3072 sc1
  v_exp_f32 v196, v196
  v_exp_f32 v197, v197
  v_exp_f32 v198, v198
  v_exp_f32 v199, v199
  v_cvt_pk_bf16_f32 v210, v196, v197
  v_cvt_pk_bf16_f32 v211, v198, v199
  s_waitcnt vmcnt(22)
  v_mfma_f32_32x32x16_bf16 v[176:191], a[52:55], v[20:23], v[176:191]
  v_exp_f32 v200, v200
  v_exp_f32 v201, v201
  v_exp_f32 v202, v202
  v_exp_f32 v203, v203
  v_cvt_pk_bf16_f32 v212, v200, v201
  v_cvt_pk_bf16_f32 v213, v202, v203
  v_mfma_f32_32x32x16_bf16 v[160:175], a[40:43], v[208:211], v[160:175]
  v_exp_f32 v204, v204
  v_exp_f32 v205, v205
  v_exp_f32 v206, v206
  v_exp_f32 v207, v207
  v_cvt_pk_bf16_f32 v214, v204, v205
  v_cvt_pk_bf16_f32 v215, v206, v207
  v_exp_f32 v176, v176
  v_exp_f32 v177, v177
  v_mfma_f32_32x32x16_bf16 v[160:175], a[44:47], v[212:215], v[160:175]
  v_exp_f32 v178, v178
  v_exp_f32 v179, v179
  v_cvt_pk_bf16_f32 v208, v176, v177
  v_cvt_pk_bf16_f32 v209, v178, v179
  v_mfma_f32_32x32x16_bf16 v[192:207], a[48:51], v[24:27], v[64:79]
  s_add_u32 s96, s96, 4096
  buffer_load_dwordx4 a[112:115], v1, s[8:11], s96 offen offset:0 sc1
  buffer_load_dwordx4 a[116:119], v1, s[8:11], s96 offen offset:1024 sc1
  v_exp_f32 v180, v180
  v_exp_f32 v181, v181
  v_exp_f32 v182, v182
  v_exp_f32 v183, v183
  v_cvt_pk_bf16_f32 v210, v180, v181
  v_cvt_pk_bf16_f32 v211, v182, v183
  v_mfma_f32_32x32x16_bf16 v[192:207], a[52:55], v[28:31], v[192:207]
  v_exp_f32 v184, v184
  v_exp_f32 v185, v185
  v_exp_f32 v186, v186
  v_exp_f32 v187, v187
  v_cvt_pk_bf16_f32 v212, v184, v185
  v_cvt_pk_bf16_f32 v213, v186, v187
  s_waitcnt vmcnt(23)
  v_mfma_f32_32x32x16_bf16 v[112:127], a[56:59], v[208:211], v[112:127]
  v_exp_f32 v188, v188
  v_exp_f32 v189, v189
  v_exp_f32 v190, v190
  v_exp_f32 v191, v191
  v_cvt_pk_bf16_f32 v214, v188, v189
  v_cvt_pk_bf16_f32 v215, v190, v191
  v_exp_f32 v192, v192
  v_exp_f32 v193, v193
  s_waitcnt vmcnt(22)
  v_mfma_f32_32x32x16_bf16 v[112:127], a[60:63], v[212:215], v[112:127]
  v_exp_f32 v194, v194
  v_exp_f32 v195, v195
  v_cvt_pk_bf16_f32 v208, v192, v193
  v_cvt_pk_bf16_f32 v209, v194, v195
  v_mfma_f32_32x32x16_bf16 v[176:191], a[48:51], v[32:35], v[80:95]
  buffer_load_dwordx4 a[32:35], v1, s[8:11], s37 offen offset:0 sc1
  buffer_load_dwordx4 a[36:39], v1, s[8:11], s37 offen offset:1024 sc1
  buffer_load_dwordx4 a[40:43], v1, s[8:11], s37 offen offset:2048 sc1
  buffer_load_dwordx4 a[44:47], v1, s[8:11], s37 offen offset:3072 sc1
  s_add_u32 s37, s37, 4096
  v_exp_f32 v196, v196
  v_exp_f32 v197, v197
  v_exp_f32 v198, v198
  v_exp_f32 v199, v199
  v_cvt_pk_bf16_f32 v210, v196, v197
  v_cvt_pk_bf16_f32 v211, v198, v199
  v_mfma_f32_32x32x16_bf16 v[176:191], a[52:55], v[36:39], v[176:191]
  v_exp_f32 v200, v200
  v_exp_f32 v201, v201
  v_exp_f32 v202, v202
  v_exp_f32 v203, v203
  v_cvt_pk_bf16_f32 v212, v200, v201
  v_cvt_pk_bf16_f32 v213, v202, v203
  v_mfma_f32_32x32x16_bf16 v[128:143], a[56:59], v[208:211], v[128:143]
  v_exp_f32 v204, v204
  v_exp_f32 v205, v205
  v_exp_f32 v206, v206
  v_exp_f32 v207, v207
  v_cvt_pk_bf16_f32 v214, v204, v205
  v_cvt_pk_bf16_f32 v215, v206, v207
  v_exp_f32 v176, v176
  v_exp_f32 v177, v177
  v_mfma_f32_32x32x16_bf16 v[128:143], a[60:63], v[212:215], v[128:143]
  v_exp_f32 v178, v178
  v_exp_f32 v179, v179
  v_cvt_pk_bf16_f32 v208, v176, v177
  v_cvt_pk_bf16_f32 v209, v178, v179
  v_mfma_f32_32x32x16_bf16 v[192:207], a[48:51], v[40:43], v[96:111]
  buffer_load_dwordx4 a[120:123], v1, s[8:11], s96 offen offset:2048 sc1
  buffer_load_dwordx4 a[124:127], v1, s[8:11], s96 offen offset:3072 sc1
  s_mul_i32 s96, s83, 118784
  s_add_u32 s96, s96, 1949696
  s_mul_i32 s97, s3, 22528
  s_add_u32 s96, s96, s97
  s_add_u32 s97, s97, 53248
  s_mov_b32 m0, s97
  s_nop 0
  buffer_load_dwordx4 v1, s[8:11], s96 offen offset:0 sc1 lds
  v_exp_f32 v180, v180
  v_exp_f32 v181, v181
  v_exp_f32 v182, v182
  v_exp_f32 v183, v183
  v_cvt_pk_bf16_f32 v210, v180, v181
  v_cvt_pk_bf16_f32 v211, v182, v183
  v_mfma_f32_32x32x16_bf16 v[192:207], a[52:55], v[44:47], v[192:207]
  v_exp_f32 v184, v184
  v_exp_f32 v185, v185
  v_exp_f32 v186, v186
  v_exp_f32 v187, v187
  v_cvt_pk_bf16_f32 v212, v184, v185
  v_cvt_pk_bf16_f32 v213, v186, v187
  v_mfma_f32_32x32x16_bf16 v[144:159], a[56:59], v[208:211], v[144:159]
  v_exp_f32 v188, v188
  v_exp_f32 v189, v189
  v_exp_f32 v190, v190
  v_exp_f32 v191, v191
  v_cvt_pk_bf16_f32 v214, v188, v189
  v_cvt_pk_bf16_f32 v215, v190, v191
  v_exp_f32 v192, v192
  v_exp_f32 v193, v193
  v_mfma_f32_32x32x16_bf16 v[144:159], a[60:63], v[212:215], v[144:159]
  v_exp_f32 v194, v194
  v_exp_f32 v195, v195
  v_cvt_pk_bf16_f32 v208, v192, v193
  v_cvt_pk_bf16_f32 v209, v194, v195
  s_waitcnt vmcnt(28)
  v_mfma_f32_32x32x16_bf16 v[176:191], a[0:3], v[16:19], v[48:63]
  buffer_load_dwordx4 v1, s[8:11], s96 offen offset:1024 sc1 lds
  buffer_load_dwordx4 v1, s[8:11], s96 offen offset:2048 sc1 lds
  v_exp_f32 v196, v196
  v_exp_f32 v197, v197
  v_exp_f32 v198, v198
  v_exp_f32 v199, v199
  v_cvt_pk_bf16_f32 v210, v196, v197
  v_cvt_pk_bf16_f32 v211, v198, v199
  s_waitcnt vmcnt(29)
  v_mfma_f32_32x32x16_bf16 v[176:191], a[4:7], v[20:23], v[176:191]
  v_exp_f32 v200, v200
  v_exp_f32 v201, v201
  v_exp_f32 v202, v202
  v_exp_f32 v203, v203
  v_cvt_pk_bf16_f32 v212, v200, v201
  v_cvt_pk_bf16_f32 v213, v202, v203
  v_mfma_f32_32x32x16_bf16 v[160:175], a[56:59], v[208:211], v[160:175]
  v_exp_f32 v204, v204
  v_exp_f32 v205, v205
  v_exp_f32 v206, v206
  v_exp_f32 v207, v207
  v_cvt_pk_bf16_f32 v214, v204, v205
  v_cvt_pk_bf16_f32 v215, v206, v207
  v_exp_f32 v176, v176
  v_exp_f32 v177, v177
  v_mfma_f32_32x32x16_bf16 v[160:175], a[60:63], v[212:215], v[160:175]
  v_exp_f32 v178, v178
  v_exp_f32 v179, v179
  v_cvt_pk_bf16_f32 v208, v176, v177
  v_cvt_pk_bf16_f32 v209, v178, v179
  v_mfma_f32_32x32x16_bf16 v[192:207], a[0:3], v[24:27], v[64:79]
  buffer_load_dwordx4 v1, s[8:11], s96 offen offset:3072 sc1 lds
  v_exp_f32 v180, v180
  v_exp_f32 v181, v181
  v_exp_f32 v182, v182
  v_exp_f32 v183, v183
  v_cvt_pk_bf16_f32 v210, v180, v181
  v_cvt_pk_bf16_f32 v211, v182, v183
  v_mfma_f32_32x32x16_bf16 v[192:207], a[4:7], v[28:31], v[192:207]
  v_exp_f32 v184, v184
  v_exp_f32 v185, v185
  v_exp_f32 v186, v186
  v_exp_f32 v187, v187
  v_cvt_pk_bf16_f32 v212, v184, v185
  v_cvt_pk_bf16_f32 v213, v186, v187
  s_waitcnt vmcnt(29)
  v_mfma_f32_32x32x16_bf16 v[112:127], a[8:11], v[208:211], v[112:127]
  v_exp_f32 v188, v188
  v_exp_f32 v189, v189
  v_exp_f32 v190, v190
  v_exp_f32 v191, v191
  v_cvt_pk_bf16_f32 v214, v188, v189
  v_cvt_pk_bf16_f32 v215, v190, v191
  v_exp_f32 v192, v192
  v_exp_f32 v193, v193
  s_waitcnt vmcnt(28)
  v_mfma_f32_32x32x16_bf16 v[112:127], a[12:15], v[212:215], v[112:127]
  v_exp_f32 v194, v194
  v_exp_f32 v195, v195
  v_cvt_pk_bf16_f32 v208, v192, v193
  v_cvt_pk_bf16_f32 v209, v194, v195
  v_mfma_f32_32x32x16_bf16 v[176:191], a[0:3], v[32:35], v[80:95]
  buffer_load_dwordx4 a[48:51], v1, s[8:11], s37 offen offset:0 sc1
  buffer_load_dwordx4 a[52:55], v1, s[8:11], s37 offen offset:1024 sc1
  buffer_load_dwordx4 a[56:59], v1, s[8:11], s37 offen offset:2048 sc1
  buffer_load_dwordx4 a[60:63], v1, s[8:11], s37 offen offset:3072 sc1
  s_add_u32 s37, s37, 4096
  v_exp_f32 v196, v196
  v_exp_f32 v197, v197
  v_exp_f32 v198, v198
  v_exp_f32 v199, v199
  v_cvt_pk_bf16_f32 v210, v196, v197
  v_cvt_pk_bf16_f32 v211, v198, v199
  v_mfma_f32_32x32x16_bf16 v[176:191], a[4:7], v[36:39], v[176:191]
  v_exp_f32 v200, v200
  v_exp_f32 v201, v201
  v_exp_f32 v202, v202
  v_exp_f32 v203, v203
  v_cvt_pk_bf16_f32 v212, v200, v201
  v_cvt_pk_bf16_f32 v213, v202, v203
  v_mfma_f32_32x32x16_bf16 v[128:143], a[8:11], v[208:211], v[128:143]
  v_exp_f32 v204, v204
  v_exp_f32 v205, v205
  v_exp_f32 v206, v206
  v_exp_f32 v207, v207
  v_cvt_pk_bf16_f32 v214, v204, v205
  v_cvt_pk_bf16_f32 v215, v206, v207
  v_exp_f32 v176, v176
  v_exp_f32 v177, v177
  v_mfma_f32_32x32x16_bf16 v[128:143], a[12:15], v[212:215], v[128:143]
  v_exp_f32 v178, v178
  v_exp_f32 v179, v179
  v_cvt_pk_bf16_f32 v208, v176, v177
  v_cvt_pk_bf16_f32 v209, v178, v179
  v_mfma_f32_32x32x16_bf16 v[192:207], a[0:3], v[40:43], v[96:111]
  s_add_u32 s96, s96, 4096
  s_add_u32 s97, s97, 4096
  s_mov_b32 m0, s97
  s_nop 0
  buffer_load_dwordx4 v1, s[8:11], s96 offen offset:0 sc1 lds
  buffer_load_dwordx4 v1, s[8:11], s96 offen offset:1024 sc1 lds
  buffer_load_dwordx4 v1, s[8:11], s96 offen offset:2048 sc1 lds
  buffer_load_dwordx4 v1, s[8:11], s96 offen offset:3072 sc1 lds
  v_exp_f32 v180, v180
  v_exp_f32 v181, v181
  v_exp_f32 v182, v182
  v_exp_f32 v183, v183
  v_cvt_pk_bf16_f32 v210, v180, v181
  v_cvt_pk_bf16_f32 v211, v182, v183
  v_mfma_f32_32x32x16_bf16 v[192:207], a[4:7], v[44:47], v[192:207]
  v_exp_f32 v184, v184
  v_exp_f32 v185, v185
  v_exp_f32 v186, v186
  v_exp_f32 v187, v187
  v_cvt_pk_bf16_f32 v212, v184, v185
  v_cvt_pk_bf16_f32 v213, v186, v187
  v_mfma_f32_32x32x16_bf16 v[144:159], a[8:11], v[208:211], v[144:159]
  v_exp_f32 v188, v188
  v_exp_f32 v189, v189
  v_exp_f32 v190, v190
  v_exp_f32 v191, v191
  v_cvt_pk_bf16_f32 v214, v188, v189
  v_cvt_pk_bf16_f32 v215, v190, v191
  v_exp_f32 v192, v192
  v_exp_f32 v193, v193
  v_mfma_f32_32x32x16_bf16 v[144:159], a[12:15], v[212:215], v[144:159]
  v_exp_f32 v194, v194
  v_exp_f32 v195, v195
  v_cvt_pk_bf16_f32 v208, v192, v193
  v_cvt_pk_bf16_f32 v209, v194, v195
  s_waitcnt vmcnt(28)
  v_mfma_f32_32x32x16_bf16 v[176:191], a[16:19], v[16:19], v[48:63]
  s_add_u32 s96, s96, 4096
  s_add_u32 s97, s97, 4096
  s_mov_b32 m0, s97
  s_nop 0
  buffer_load_dwordx4 v1, s[8:11], s96 offen offset:0 sc1 lds
  v_exp_f32 v196, v196
  v_exp_f32 v197, v197
  v_exp_f32 v198, v198
  v_exp_f32 v199, v199
  v_cvt_pk_bf16_f32 v210, v196, v197
  v_cvt_pk_bf16_f32 v211, v198, v199
  s_waitcnt vmcnt(28)
  v_mfma_f32_32x32x16_bf16 v[176:191], a[20:23], v[20:23], v[176:191]
  v_exp_f32 v200, v200
  v_exp_f32 v201, v201
  v_exp_f32 v202, v202
  v_exp_f32 v203, v203
  v_cvt_pk_bf16_f32 v212, v200, v201
  v_cvt_pk_bf16_f32 v213, v202, v203
  v_mfma_f32_32x32x16_bf16 v[160:175], a[8:11], v[208:211], v[160:175]
  v_exp_f32 v204, v204
  v_exp_f32 v205, v205
  v_exp_f32 v206, v206
  v_exp_f32 v207, v207
  v_cvt_pk_bf16_f32 v214, v204, v205
  v_cvt_pk_bf16_f32 v215, v206, v207
  v_exp_f32 v176, v176
  v_exp_f32 v177, v177
  v_mfma_f32_32x32x16_bf16 v[160:175], a[12:15], v[212:215], v[160:175]
  v_exp_f32 v178, v178
  v_exp_f32 v179, v179
  v_cvt_pk_bf16_f32 v208, v176, v177
  v_cvt_pk_bf16_f32 v209, v178, v179
  v_mfma_f32_32x32x16_bf16 v[192:207], a[16:19], v[24:27], v[64:79]
  buffer_load_dwordx4 v1, s[8:11], s96 offen offset:1024 sc1 lds
  buffer_load_dwordx4 v1, s[8:11], s96 offen offset:2048 sc1 lds
  v_exp_f32 v180, v180
  v_exp_f32 v181, v181
  v_exp_f32 v182, v182
  v_exp_f32 v183, v183
  v_cvt_pk_bf16_f32 v210, v180, v181
  v_cvt_pk_bf16_f32 v211, v182, v183
  v_mfma_f32_32x32x16_bf16 v[192:207], a[20:23], v[28:31], v[192:207]
  v_exp_f32 v184, v184
  v_exp_f32 v185, v185
  v_exp_f32 v186, v186
  v_exp_f32 v187, v187
  v_cvt_pk_bf16_f32 v212, v184, v185
  v_cvt_pk_bf16_f32 v213, v186, v187
  s_waitcnt vmcnt(29)
  v_mfma_f32_32x32x16_bf16 v[112:127], a[24:27], v[208:211], v[112:127]
  v_exp_f32 v188, v188
  v_exp_f32 v189, v189
  v_exp_f32 v190, v190
  v_exp_f32 v191, v191
  v_cvt_pk_bf16_f32 v214, v188, v189
  v_cvt_pk_bf16_f32 v215, v190, v191
  v_exp_f32 v192, v192
  v_exp_f32 v193, v193
  s_waitcnt vmcnt(28)
  v_mfma_f32_32x32x16_bf16 v[112:127], a[28:31], v[212:215], v[112:127]
  v_exp_f32 v194, v194
  v_exp_f32 v195, v195
  v_cvt_pk_bf16_f32 v208, v192, v193
  v_cvt_pk_bf16_f32 v209, v194, v195
  v_mfma_f32_32x32x16_bf16 v[176:191], a[16:19], v[32:35], v[80:95]
  buffer_load_dwordx4 a[0:3], v1, s[8:11], s37 offen offset:0 sc1
  buffer_load_dwordx4 a[4:7], v1, s[8:11], s37 offen offset:1024 sc1
  buffer_load_dwordx4 a[8:11], v1, s[8:11], s37 offen offset:2048 sc1
  buffer_load_dwordx4 a[12:15], v1, s[8:11], s37 offen offset:3072 sc1
  s_add_u32 s37, s37, 4096
  v_exp_f32 v196, v196
  v_exp_f32 v197, v197
  v_exp_f32 v198, v198
  v_exp_f32 v199, v199
  v_cvt_pk_bf16_f32 v210, v196, v197
  v_cvt_pk_bf16_f32 v211, v198, v199
  v_mfma_f32_32x32x16_bf16 v[176:191], a[20:23], v[36:39], v[176:191]
  v_exp_f32 v200, v200
  v_exp_f32 v201, v201
  v_exp_f32 v202, v202
  v_exp_f32 v203, v203
  v_cvt_pk_bf16_f32 v212, v200, v201
  v_cvt_pk_bf16_f32 v213, v202, v203
  v_mfma_f32_32x32x16_bf16 v[128:143], a[24:27], v[208:211], v[128:143]
  v_exp_f32 v204, v204
  v_exp_f32 v205, v205
  v_exp_f32 v206, v206
  v_exp_f32 v207, v207
  v_cvt_pk_bf16_f32 v214, v204, v205
  v_cvt_pk_bf16_f32 v215, v206, v207
  v_exp_f32 v176, v176
  v_exp_f32 v177, v177
  v_mfma_f32_32x32x16_bf16 v[128:143], a[28:31], v[212:215], v[128:143]
  v_exp_f32 v178, v178
  v_exp_f32 v179, v179
  v_cvt_pk_bf16_f32 v208, v176, v177
  v_cvt_pk_bf16_f32 v209, v178, v179
  v_mfma_f32_32x32x16_bf16 v[192:207], a[16:19], v[40:43], v[96:111]
  buffer_load_dwordx4 v1, s[8:11], s96 offen offset:3072 sc1 lds
  s_add_u32 s96, s96, 4096
  s_add_u32 s97, s97, 4096
  s_mov_b32 m0, s97
  s_nop 0
  buffer_load_dwordx4 v1, s[8:11], s96 offen offset:0 sc1 lds
  buffer_load_dwordx4 v1, s[8:11], s96 offen offset:1024 sc1 lds
  v_exp_f32 v180, v180
  v_exp_f32 v181, v181
  v_exp_f32 v182, v182
  v_exp_f32 v183, v183
  v_cvt_pk_bf16_f32 v210, v180, v181
  v_cvt_pk_bf16_f32 v211, v182, v183
  v_mfma_f32_32x32x16_bf16 v[192:207], a[20:23], v[44:47], v[192:207]
  v_exp_f32 v184, v184
  v_exp_f32 v185, v185
  v_exp_f32 v186, v186
  v_exp_f32 v187, v187
  v_cvt_pk_bf16_f32 v212, v184, v185
  v_cvt_pk_bf16_f32 v213, v186, v187
  v_mfma_f32_32x32x16_bf16 v[144:159], a[24:27], v[208:211], v[144:159]
  v_exp_f32 v188, v188
  v_exp_f32 v189, v189
  v_exp_f32 v190, v190
  v_exp_f32 v191, v191
  v_cvt_pk_bf16_f32 v214, v188, v189
  v_cvt_pk_bf16_f32 v215, v190, v191
  v_exp_f32 v192, v192
  v_exp_f32 v193, v193
  v_mfma_f32_32x32x16_bf16 v[144:159], a[28:31], v[212:215], v[144:159]
  v_exp_f32 v194, v194
  v_exp_f32 v195, v195
  v_cvt_pk_bf16_f32 v208, v192, v193
  v_cvt_pk_bf16_f32 v209, v194, v195
  s_waitcnt vmcnt(27)
  v_mfma_f32_32x32x16_bf16 v[176:191], a[32:35], v[16:19], v[48:63]
  buffer_load_dwordx4 v1, s[8:11], s96 offen offset:2048 sc1 lds
  buffer_load_dwordx4 v1, s[8:11], s96 offen offset:3072 sc1 lds
  v_exp_f32 v196, v196
  v_exp_f32 v197, v197
  v_exp_f32 v198, v198
  v_exp_f32 v199, v199
  v_cvt_pk_bf16_f32 v210, v196, v197
  v_cvt_pk_bf16_f32 v211, v198, v199
  s_waitcnt vmcnt(28)
  v_mfma_f32_32x32x16_bf16 v[176:191], a[36:39], v[20:23], v[176:191]
  v_exp_f32 v200, v200
  v_exp_f32 v201, v201
  v_exp_f32 v202, v202
  v_exp_f32 v203, v203
  v_cvt_pk_bf16_f32 v212, v200, v201
  v_cvt_pk_bf16_f32 v213, v202, v203
  v_mfma_f32_32x32x16_bf16 v[160:175], a[24:27], v[208:211], v[160:175]
  v_exp_f32 v204, v204
  v_exp_f32 v205, v205
  v_exp_f32 v206, v206
  v_exp_f32 v207, v207
  v_cvt_pk_bf16_f32 v214, v204, v205
  v_cvt_pk_bf16_f32 v215, v206, v207
  v_exp_f32 v176, v176
  v_exp_f32 v177, v177
  v_mfma_f32_32x32x16_bf16 v[160:175], a[28:31], v[212:215], v[160:175]
  v_exp_f32 v178, v178
  v_exp_f32 v179, v179
  v_cvt_pk_bf16_f32 v208, v176, v177
  v_cvt_pk_bf16_f32 v209, v178, v179
  v_mfma_f32_32x32x16_bf16 v[192:207], a[32:35], v[24:27], v[64:79]
  s_add_u32 s96, s96, 4096
  s_add_u32 s97, s97, 4096
  s_mov_b32 m0, s97
  s_nop 0
  buffer_load_dwordx4 v1, s[8:11], s96 offen offset:0 sc1 lds
  buffer_load_dwordx4 v1, s[8:11], s96 offen offset:1024 sc1 lds
  v_exp_f32 v180, v180
  v_exp_f32 v181, v181
  v_exp_f32 v182, v182
  v_exp_f32 v183, v183
  v_cvt_pk_bf16_f32 v210, v180, v181
  v_cvt_pk_bf16_f32 v211, v182, v183
  v_mfma_f32_32x32x16_bf16 v[192:207], a[36:39], v[28:31], v[192:207]
  v_exp_f32 v184, v184
  v_exp_f32 v185, v185
  v_exp_f32 v186, v186
  v_exp_f32 v187, v187
  v_cvt_pk_bf16_f32 v212, v184, v185
  v_cvt_pk_bf16_f32 v213, v186, v187
  s_waitcnt vmcnt(29)
  v_mfma_f32_32x32x16_bf16 v[112:127], a[40:43], v[208:211], v[112:127]
  v_exp_f32 v188, v188
  v_exp_f32 v189, v189
  v_exp_f32 v190, v190
  v_exp_f32 v191, v191
  v_cvt_pk_bf16_f32 v214, v188, v189
  v_cvt_pk_bf16_f32 v215, v190, v191
  v_exp_f32 v192, v192
  v_exp_f32 v193, v193
  s_waitcnt vmcnt(28)
  v_mfma_f32_32x32x16_bf16 v[112:127], a[44:47], v[212:215], v[112:127]
  v_exp_f32 v194, v194
  v_exp_f32 v195, v195
  v_cvt_pk_bf16_f32 v208, v192, v193
  v_cvt_pk_bf16_f32 v209, v194, v195
  v_mfma_f32_32x32x16_bf16 v[176:191], a[32:35], v[32:35], v[80:95]
  buffer_load_dwordx4 a[16:19], v1, s[8:11], s37 offen offset:0 sc1
  buffer_load_dwordx4 a[20:23], v1, s[8:11], s37 offen offset:1024 sc1
  buffer_load_dwordx4 a[24:27], v1, s[8:11], s37 offen offset:2048 sc1
  buffer_load_dwordx4 a[28:31], v1, s[8:11], s37 offen offset:3072 sc1
  s_add_u32 s37, s37, 4096
  v_exp_f32 v196, v196
  v_exp_f32 v197, v197
  v_exp_f32 v198, v198
  v_exp_f32 v199, v199
  v_cvt_pk_bf16_f32 v210, v196, v197
  v_cvt_pk_bf16_f32 v211, v198, v199
  v_mfma_f32_32x32x16_bf16 v[176:191], a[36:39], v[36:39], v[176:191]
  v_exp_f32 v200, v200
  v_exp_f32 v201, v201
  v_exp_f32 v202, v202
  v_exp_f32 v203, v203
  v_cvt_pk_bf16_f32 v212, v200, v201
  v_cvt_pk_bf16_f32 v213, v202, v203
  v_mfma_f32_32x32x16_bf16 v[128:143], a[40:43], v[208:211], v[128:143]
  v_exp_f32 v204, v204
  v_exp_f32 v205, v205
  v_exp_f32 v206, v206
  v_exp_f32 v207, v207
  v_cvt_pk_bf16_f32 v214, v204, v205
  v_cvt_pk_bf16_f32 v215, v206, v207
  v_exp_f32 v176, v176
  v_exp_f32 v177, v177
  v_mfma_f32_32x32x16_bf16 v[128:143], a[44:47], v[212:215], v[128:143]
  v_exp_f32 v178, v178
  v_exp_f32 v179, v179
  v_cvt_pk_bf16_f32 v208, v176, v177
  v_cvt_pk_bf16_f32 v209, v178, v179
  v_mfma_f32_32x32x16_bf16 v[192:207], a[32:35], v[40:43], v[96:111]
  buffer_load_dwordx4 v1, s[8:11], s96 offen offset:2048 sc1 lds
  buffer_load_dwordx4 v1, s[8:11], s96 offen offset:3072 sc1 lds
  s_add_u32 s96, s96, 4096
  s_add_u32 s97, s97, 4096
  s_mov_b32 m0, s97
  s_nop 0
  buffer_load_dwordx4 v1, s[8:11], s96 offen offset:0 sc1 lds
  v_exp_f32 v180, v180
  v_exp_f32 v181, v181
  v_exp_f32 v182, v182
  v_exp_f32 v183, v183
  v_cvt_pk_bf16_f32 v210, v180, v181
  v_cvt_pk_bf16_f32 v211, v182, v183
  v_mfma_f32_32x32x16_bf16 v[192:207], a[36:39], v[44:47], v[192:207]
  v_exp_f32 v184, v184
  v_exp_f32 v185, v185
  v_exp_f32 v186, v186
  v_exp_f32 v187, v187
  v_cvt_pk_bf16_f32 v212, v184, v185
  v_cvt_pk_bf16_f32 v213, v186, v187
  v_mfma_f32_32x32x16_bf16 v[144:159], a[40:43], v[208:211], v[144:159]
  v_exp_f32 v188, v188
  v_exp_f32 v189, v189
  v_exp_f32 v190, v190
  v_exp_f32 v191, v191
  v_cvt_pk_bf16_f32 v214, v188, v189
  v_cvt_pk_bf16_f32 v215, v190, v191
  v_exp_f32 v192, v192
  v_exp_f32 v193, v193
  v_mfma_f32_32x32x16_bf16 v[144:159], a[44:47], v[212:215], v[144:159]
  v_exp_f32 v194, v194
  v_exp_f32 v195, v195
  v_cvt_pk_bf16_f32 v208, v192, v193
  v_cvt_pk_bf16_f32 v209, v194, v195
  s_waitcnt vmcnt(28)
  v_mfma_f32_32x32x16_bf16 v[176:191], a[48:51], v[16:19], v[48:63]
  buffer_load_dwordx4 v1, s[8:11], s96 offen offset:1024 sc1 lds
  s_and_b32 s98, s3, 1
  s_xor_b32 s98, s98, 0
  s_lshl_b32 s99, s81, 1
  s_add_u32 s98, s98, s99
  s_mul_i32 s98, s98, 112
  s_mul_i32 s99, s3, 28
  s_add_u32 s98, s98, s99
  s_lshl_b32 s98, s98, 10
  s_add_u32 s96, s98, 3612672
  buffer_load_dwordx4 a[128:131], v1, s[8:11], s96 offen offset:0 sc1
  v_exp_f32 v196, v196
  v_exp_f32 v197, v197
  v_exp_f32 v198, v198
  v_exp_f32 v199, v199
  v_cvt_pk_bf16_f32 v210, v196, v197
  v_cvt_pk_bf16_f32 v211, v198, v199
  s_waitcnt vmcnt(29)
  v_mfma_f32_32x32x16_bf16 v[176:191], a[52:55], v[20:23], v[176:191]
  v_exp_f32 v200, v200
  v_exp_f32 v201, v201
  v_exp_f32 v202, v202
  v_exp_f32 v203, v203
  v_cvt_pk_bf16_f32 v212, v200, v201
  v_cvt_pk_bf16_f32 v213, v202, v203
  v_mfma_f32_32x32x16_bf16 v[160:175], a[40:43], v[208:211], v[160:175]
  v_exp_f32 v204, v204
  v_exp_f32 v205, v205
  v_exp_f32 v206, v206
  v_exp_f32 v207, v207
  v_cvt_pk_bf16_f32 v214, v204, v205
  v_cvt_pk_bf16_f32 v215, v206, v207
  v_exp_f32 v176, v176
  v_exp_f32 v177, v177
  v_mfma_f32_32x32x16_bf16 v[160:175], a[44:47], v[212:215], v[160:175]
  v_exp_f32 v178, v178
  v_exp_f32 v179, v179
  v_cvt_pk_bf16_f32 v208, v176, v177
  v_cvt_pk_bf16_f32 v209, v178, v179
  v_mfma_f32_32x32x16_bf16 v[192:207], a[48:51], v[24:27], v[64:79]
  buffer_load_dwordx4 a[136:139], v1, s[8:11], s96 offen offset:1024 sc1
  v_exp_f32 v180, v180
  v_exp_f32 v181, v181
  v_exp_f32 v182, v182
  v_exp_f32 v183, v183
  v_cvt_pk_bf16_f32 v210, v180, v181
  v_cvt_pk_bf16_f32 v211, v182, v183
  v_mfma_f32_32x32x16_bf16 v[192:207], a[52:55], v[28:31], v[192:207]
  v_exp_f32 v184, v184
  v_exp_f32 v185, v185
  v_exp_f32 v186, v186
  v_exp_f32 v187, v187
  v_cvt_pk_bf16_f32 v212, v184, v185
  v_cvt_pk_bf16_f32 v213, v186, v187
  s_waitcnt vmcnt(29)
  v_mfma_f32_32x32x16_bf16 v[112:127], a[56:59], v[208:211], v[112:127]
  v_exp_f32 v188, v188
  v_exp_f32 v189, v189
  v_exp_f32 v190, v190
  v_exp_f32 v191, v191
  v_cvt_pk_bf16_f32 v214, v188, v189
  v_cvt_pk_bf16_f32 v215, v190, v191
  v_exp_f32 v192, v192
  v_exp_f32 v193, v193
  s_waitcnt vmcnt(28)
  v_mfma_f32_32x32x16_bf16 v[112:127], a[60:63], v[212:215], v[112:127]
  v_exp_f32 v194, v194
  v_exp_f32 v195, v195
  v_cvt_pk_bf16_f32 v208, v192, v193
  v_cvt_pk_bf16_f32 v209, v194, v195
  v_mfma_f32_32x32x16_bf16 v[176:191], a[48:51], v[32:35], v[80:95]
  buffer_load_dwordx4 a[32:35], v1, s[8:11], s37 offen offset:0 sc1
  buffer_load_dwordx4 a[36:39], v1, s[8:11], s37 offen offset:1024 sc1
  buffer_load_dwordx4 a[40:43], v1, s[8:11], s37 offen offset:2048 sc1
  buffer_load_dwordx4 a[44:47], v1, s[8:11], s37 offen offset:3072 sc1
  s_add_u32 s37, s37, 4096
  v_exp_f32 v196, v196
  v_exp_f32 v197, v197
  v_exp_f32 v198, v198
  v_exp_f32 v199, v199
  v_cvt_pk_bf16_f32 v210, v196, v197
  v_cvt_pk_bf16_f32 v211, v198, v199
  v_mfma_f32_32x32x16_bf16 v[176:191], a[52:55], v[36:39], v[176:191]
  v_exp_f32 v200, v200
  v_exp_f32 v201, v201
  v_exp_f32 v202, v202
  v_exp_f32 v203, v203
  v_cvt_pk_bf16_f32 v212, v200, v201
  v_cvt_pk_bf16_f32 v213, v202, v203
  v_mfma_f32_32x32x16_bf16 v[128:143], a[56:59], v[208:211], v[128:143]
  v_exp_f32 v204, v204
  v_exp_f32 v205, v205
  v_exp_f32 v206, v206
  v_exp_f32 v207, v207
  v_cvt_pk_bf16_f32 v214, v204, v205
  v_cvt_pk_bf16_f32 v215, v206, v207
  v_exp_f32 v176, v176
  v_exp_f32 v177, v177
  v_mfma_f32_32x32x16_bf16 v[128:143], a[60:63], v[212:215], v[128:143]
  v_exp_f32 v178, v178
  v_exp_f32 v179, v179
  v_cvt_pk_bf16_f32 v208, v176, v177
  v_cvt_pk_bf16_f32 v209, v178, v179
  v_mfma_f32_32x32x16_bf16 v[192:207], a[48:51], v[40:43], v[96:111]
  buffer_load_dwordx4 a[144:147], v1, s[8:11], s96 offen offset:2048 sc1
  buffer_load_dwordx4 a[152:155], v1, s[8:11], s96 offen offset:3072 sc1
  s_add_u32 s96, s96, 4096
  buffer_load_dwordx4 a[160:163], v1, s[8:11], s96 offen offset:0 sc1
  buffer_load_dwordx4 a[168:171], v1, s[8:11], s96 offen offset:1024 sc1
  v_exp_f32 v180, v180
  v_exp_f32 v181, v181
  v_exp_f32 v182, v182
  v_exp_f32 v183, v183
  v_cvt_pk_bf16_f32 v210, v180, v181
  v_cvt_pk_bf16_f32 v211, v182, v183
  v_mfma_f32_32x32x16_bf16 v[192:207], a[52:55], v[44:47], v[192:207]
  v_exp_f32 v184, v184
  v_exp_f32 v185, v185
  v_exp_f32 v186, v186
  v_exp_f32 v187, v187
  v_cvt_pk_bf16_f32 v212, v184, v185
  v_cvt_pk_bf16_f32 v213, v186, v187
  v_mfma_f32_32x32x16_bf16 v[144:159], a[56:59], v[208:211], v[144:159]
  v_exp_f32 v188, v188
  v_exp_f32 v189, v189
  v_exp_f32 v190, v190
  v_exp_f32 v191, v191
  v_cvt_pk_bf16_f32 v214, v188, v189
  v_cvt_pk_bf16_f32 v215, v190, v191
  v_exp_f32 v192, v192
  v_exp_f32 v193, v193
  v_mfma_f32_32x32x16_bf16 v[144:159], a[60:63], v[212:215], v[144:159]
  v_exp_f32 v194, v194
  v_exp_f32 v195, v195
  v_cvt_pk_bf16_f32 v208, v192, v193
  v_cvt_pk_bf16_f32 v209, v194, v195
  s_waitcnt vmcnt(28)
  v_mfma_f32_32x32x16_bf16 v[176:191], a[0:3], v[16:19], v[48:63]
  buffer_load_dwordx4 a[176:179], v1, s[8:11], s96 offen offset:2048 sc1
  v_exp_f32 v196, v196
  v_exp_f32 v197, v197
  v_exp_f32 v198, v198
  v_exp_f32 v199, v199
  v_cvt_pk_bf16_f32 v210, v196, v197
  v_cvt_pk_bf16_f32 v211, v198, v199
  s_waitcnt vmcnt(28)
  v_mfma_f32_32x32x16_bf16 v[176:191], a[4:7], v[20:23], v[176:191]
  v_exp_f32 v200, v200
  v_exp_f32 v201, v201
  v_exp_f32 v202, v202
  v_exp_f32 v203, v203
  v_cvt_pk_bf16_f32 v212, v200, v201
  v_cvt_pk_bf16_f32 v213, v202, v203
  v_mfma_f32_32x32x16_bf16 v[160:175], a[56:59], v[208:211], v[160:175]
  v_exp_f32 v204, v204
  v_exp_f32 v205, v205
  v_exp_f32 v206, v206
  v_exp_f32 v207, v207
  v_cvt_pk_bf16_f32 v214, v204, v205
  v_cvt_pk_bf16_f32 v215, v206, v207
  v_exp_f32 v176, v176
  v_exp_f32 v177, v177
  v_mfma_f32_32x32x16_bf16 v[160:175], a[60:63], v[212:215], v[160:175]
  v_exp_f32 v178, v178
  v_exp_f32 v179, v179
  v_cvt_pk_bf16_f32 v208, v176, v177
  v_cvt_pk_bf16_f32 v209, v178, v179
  v_mfma_f32_32x32x16_bf16 v[192:207], a[0:3], v[24:27], v[64:79]
  buffer_load_dwordx4 a[184:187], v1, s[8:11], s96 offen offset:3072 sc1
  s_add_u32 s96, s96, 4096
  buffer_load_dwordx4 a[192:195], v1, s[8:11], s96 offen offset:0 sc1
  v_exp_f32 v180, v180
  v_exp_f32 v181, v181
  v_exp_f32 v182, v182
  v_exp_f32 v183, v183
  v_cvt_pk_bf16_f32 v210, v180, v181
  v_cvt_pk_bf16_f32 v211, v182, v183
  v_mfma_f32_32x32x16_bf16 v[192:207], a[4:7], v[28:31], v[192:207]
  v_exp_f32 v184, v184
  v_exp_f32 v185, v185
  v_exp_f32 v186, v186
  v_exp_f32 v187, v187
  v_cvt_pk_bf16_f32 v212, v184, v185
  v_cvt_pk_bf16_f32 v213, v186, v187
  s_waitcnt vmcnt(29)
  v_mfma_f32_32x32x16_bf16 v[112:127], a[8:11], v[208:211], v[112:127]
  v_exp_f32 v188, v188
  v_exp_f32 v189, v189
  v_exp_f32 v190, v190
  v_exp_f32 v191, v191
  v_cvt_pk_bf16_f32 v214, v188, v189
  v_cvt_pk_bf16_f32 v215, v190, v191
  v_exp_f32 v192, v192
  v_exp_f32 v193, v193
  s_waitcnt vmcnt(28)
  v_mfma_f32_32x32x16_bf16 v[112:127], a[12:15], v[212:215], v[112:127]
  v_exp_f32 v194, v194
  v_exp_f32 v195, v195
  v_cvt_pk_bf16_f32 v208, v192, v193
  v_cvt_pk_bf16_f32 v209, v194, v195
  v_mfma_f32_32x32x16_bf16 v[176:191], a[0:3], v[32:35], v[80:95]
  buffer_load_dwordx4 a[48:51], v1, s[8:11], s37 offen offset:0 sc1
  buffer_load_dwordx4 a[52:55], v1, s[8:11], s37 offen offset:1024 sc1
  buffer_load_dwordx4 a[56:59], v1, s[8:11], s37 offen offset:2048 sc1
  buffer_load_dwordx4 a[60:63], v1, s[8:11], s37 offen offset:3072 sc1
  s_add_u32 s37, s37, 4096
  v_exp_f32 v196, v196
  v_exp_f32 v197, v197
  v_exp_f32 v198, v198
  v_exp_f32 v199, v199
  v_cvt_pk_bf16_f32 v210, v196, v197
  v_cvt_pk_bf16_f32 v211, v198, v199
  v_mfma_f32_32x32x16_bf16 v[176:191], a[4:7], v[36:39], v[176:191]
  v_exp_f32 v200, v200
  v_exp_f32 v201, v201
  v_exp_f32 v202, v202
  v_exp_f32 v203, v203
  v_cvt_pk_bf16_f32 v212, v200, v201
  v_cvt_pk_bf16_f32 v213, v202, v203
  v_mfma_f32_32x32x16_bf16 v[128:143], a[8:11], v[208:211], v[128:143]
  v_exp_f32 v204, v204
  v_exp_f32 v205, v205
  v_exp_f32 v206, v206
  v_exp_f32 v207, v207
  v_cvt_pk_bf16_f32 v214, v204, v205
  v_cvt_pk_bf16_f32 v215, v206, v207
  v_exp_f32 v176, v176
  v_exp_f32 v177, v177
  v_mfma_f32_32x32x16_bf16 v[128:143], a[12:15], v[212:215], v[128:143]
  v_exp_f32 v178, v178
  v_exp_f32 v179, v179
  v_cvt_pk_bf16_f32 v208, v176, v177
  v_cvt_pk_bf16_f32 v209, v178, v179
  v_mfma_f32_32x32x16_bf16 v[192:207], a[0:3], v[40:43], v[96:111]
  buffer_load_dwordx4 a[200:203], v1, s[8:11], s96 offen offset:1024 sc1
  buffer_load_dwordx4 a[208:211], v1, s[8:11], s96 offen offset:2048 sc1
  buffer_load_dwordx4 a[216:219], v1, s[8:11], s96 offen offset:3072 sc1
  v_exp_f32 v180, v180
  v_exp_f32 v181, v181
  v_exp_f32 v182, v182
  v_exp_f32 v183, v183
  v_cvt_pk_bf16_f32 v210, v180, v181
  v_cvt_pk_bf16_f32 v211, v182, v183
  v_mfma_f32_32x32x16_bf16 v[192:207], a[4:7], v[44:47], v[192:207]
  v_exp_f32 v184, v184
  v_exp_f32 v185, v185
  v_exp_f32 v186, v186
  v_exp_f32 v187, v187
  v_cvt_pk_bf16_f32 v212, v184, v185
  v_cvt_pk_bf16_f32 v213, v186, v187
  v_mfma_f32_32x32x16_bf16 v[144:159], a[8:11], v[208:211], v[144:159]
  v_exp_f32 v188, v188
  v_exp_f32 v189, v189
  v_exp_f32 v190, v190
  v_exp_f32 v191, v191
  v_cvt_pk_bf16_f32 v214, v188, v189
  v_cvt_pk_bf16_f32 v215, v190, v191
  v_exp_f32 v192, v192
  v_exp_f32 v193, v193
  v_mfma_f32_32x32x16_bf16 v[144:159], a[12:15], v[212:215], v[144:159]
  v_exp_f32 v194, v194
  v_exp_f32 v195, v195
  v_cvt_pk_bf16_f32 v208, v192, v193
  v_cvt_pk_bf16_f32 v209, v194, v195
  s_waitcnt vmcnt(27)
  v_mfma_f32_32x32x16_bf16 v[176:191], a[16:19], v[16:19], v[48:63]
  s_add_u32 s96, s96, 4096
  buffer_load_dwordx4 a[224:227], v1, s[8:11], s96 offen offset:0 sc1
  buffer_load_dwordx4 a[232:235], v1, s[8:11], s96 offen offset:1024 sc1
  v_exp_f32 v196, v196
  v_exp_f32 v197, v197
  v_exp_f32 v198, v198
  v_exp_f32 v199, v199
  v_cvt_pk_bf16_f32 v210, v196, v197
  v_cvt_pk_bf16_f32 v211, v198, v199
  s_waitcnt vmcnt(28)
  v_mfma_f32_32x32x16_bf16 v[176:191], a[20:23], v[20:23], v[176:191]
  v_exp_f32 v200, v200
  v_exp_f32 v201, v201
  v_exp_f32 v202, v202
  v_exp_f32 v203, v203
  v_cvt_pk_bf16_f32 v212, v200, v201
  v_cvt_pk_bf16_f32 v213, v202, v203
  v_mfma_f32_32x32x16_bf16 v[160:175], a[8:11], v[208:211], v[160:175]
  v_exp_f32 v204, v204
  v_exp_f32 v205, v205
  v_exp_f32 v206, v206
  v_exp_f32 v207, v207
  v_cvt_pk_bf16_f32 v214, v204, v205
  v_cvt_pk_bf16_f32 v215, v206, v207
  v_exp_f32 v176, v176
  v_exp_f32 v177, v177
  v_mfma_f32_32x32x16_bf16 v[160:175], a[12:15], v[212:215], v[160:175]
  v_exp_f32 v178, v178
  v_exp_f32 v179, v179
  v_cvt_pk_bf16_f32 v208, v176, v177
  v_cvt_pk_bf16_f32 v209, v178, v179
  v_mfma_f32_32x32x16_bf16 v[192:207], a[16:19], v[24:27], v[64:79]
  buffer_load_dwordx4 a[240:243], v1, s[8:11], s96 offen offset:2048 sc1
  buffer_load_dwordx4 a[248:251], v1, s[8:11], s96 offen offset:3072 sc1
  v_exp_f32 v180, v180
  v_exp_f32 v181, v181
  v_exp_f32 v182, v182
  v_exp_f32 v183, v183
  v_cvt_pk_bf16_f32 v210, v180, v181
  v_cvt_pk_bf16_f32 v211, v182, v183
  v_mfma_f32_32x32x16_bf16 v[192:207], a[20:23], v[28:31], v[192:207]
  v_exp_f32 v184, v184
  v_exp_f32 v185, v185
  v_exp_f32 v186, v186
  v_exp_f32 v187, v187
  v_cvt_pk_bf16_f32 v212, v184, v185
  v_cvt_pk_bf16_f32 v213, v186, v187
  s_waitcnt vmcnt(29)
  v_mfma_f32_32x32x16_bf16 v[112:127], a[24:27], v[208:211], v[112:127]
  v_exp_f32 v188, v188
  v_exp_f32 v189, v189
  v_exp_f32 v190, v190
  v_exp_f32 v191, v191
  v_cvt_pk_bf16_f32 v214, v188, v189
  v_cvt_pk_bf16_f32 v215, v190, v191
  v_exp_f32 v192, v192
  v_exp_f32 v193, v193
  s_waitcnt vmcnt(28)
  v_mfma_f32_32x32x16_bf16 v[112:127], a[28:31], v[212:215], v[112:127]
  v_exp_f32 v194, v194
  v_exp_f32 v195, v195
  v_cvt_pk_bf16_f32 v208, v192, v193
  v_cvt_pk_bf16_f32 v209, v194, v195
  v_mfma_f32_32x32x16_bf16 v[176:191], a[16:19], v[32:35], v[80:95]
  s_and_b32 s98, s3, 1
  s_xor_b32 s98, s98, 1
  s_lshl_b32 s99, s81, 1
  s_add_u32 s98, s98, s99
  s_mul_i32 s98, s98, 112
  s_mul_i32 s99, s3, 28
  s_add_u32 s98, s98, s99
  s_lshl_b32 s98, s98, 10
  s_add_u32 s96, s98, 3612672
  buffer_load_dwordx4 a[132:135], v1, s[8:11], s96 offen offset:0 sc1
  v_exp_f32 v196, v196
  v_exp_f32 v197, v197
  v_exp_f32 v198, v198
  v_exp_f32 v199, v199
  v_cvt_pk_bf16_f32 v210, v196, v197
  v_cvt_pk_bf16_f32 v211, v198, v199
  v_mfma_f32_32x32x16_bf16 v[176:191], a[20:23], v[36:39], v[176:191]
  v_exp_f32 v200, v200
  v_exp_f32 v201, v201
  v_exp_f32 v202, v202
  v_exp_f32 v203, v203
  v_cvt_pk_bf16_f32 v212, v200, v201
  v_cvt_pk_bf16_f32 v213, v202, v203
  v_mfma_f32_32x32x16_bf16 v[128:143], a[24:27], v[208:211], v[128:143]
  v_exp_f32 v204, v204
  v_exp_f32 v205, v205
  v_exp_f32 v206, v206
  v_exp_f32 v207, v207
  v_cvt_pk_bf16_f32 v214, v204, v205
  v_cvt_pk_bf16_f32 v215, v206, v207
  v_exp_f32 v176, v176
  v_exp_f32 v177, v177
  v_mfma_f32_32x32x16_bf16 v[128:143], a[28:31], v[212:215], v[128:143]
  v_exp_f32 v178, v178
  v_exp_f32 v179, v179
  v_cvt_pk_bf16_f32 v208, v176, v177
  v_cvt_pk_bf16_f32 v209, v178, v179
  v_mfma_f32_32x32x16_bf16 v[192:207], a[16:19], v[40:43], v[96:111]
  buffer_load_dwordx4 a[140:143], v1, s[8:11], s96 offen offset:1024 sc1
  buffer_load_dwordx4 a[148:151], v1, s[8:11], s96 offen offset:2048 sc1
  v_exp_f32 v180, v180
  v_exp_f32 v181, v181
  v_exp_f32 v182, v182
  v_exp_f32 v183, v183
  v_cvt_pk_bf16_f32 v210, v180, v181
  v_cvt_pk_bf16_f32 v211, v182, v183
  v_mfma_f32_32x32x16_bf16 v[192:207], a[20:23], v[44:47], v[192:207]
  v_exp_f32 v184, v184
  v_exp_f32 v185, v185
  v_exp_f32 v186, v186
  v_exp_f32 v187, v187
  v_cvt_pk_bf16_f32 v212, v184, v185
  v_cvt_pk_bf16_f32 v213, v186, v187
  v_mfma_f32_32x32x16_bf16 v[144:159], a[24:27], v[208:211], v[144:159]
  v_exp_f32 v188, v188
  v_exp_f32 v189, v189
  v_exp_f32 v190, v190
  v_exp_f32 v191, v191
  v_cvt_pk_bf16_f32 v214, v188, v189
  v_cvt_pk_bf16_f32 v215, v190, v191
  v_exp_f32 v192, v192
  v_exp_f32 v193, v193
  v_mfma_f32_32x32x16_bf16 v[144:159], a[28:31], v[212:215], v[144:159]
  v_exp_f32 v194, v194
  v_exp_f32 v195, v195
  v_cvt_pk_bf16_f32 v208, v192, v193
  v_cvt_pk_bf16_f32 v209, v194, v195
  s_waitcnt vmcnt(24)
  v_mfma_f32_32x32x16_bf16 v[176:191], a[32:35], v[16:19], v[48:63]
  buffer_load_dwordx4 a[156:159], v1, s[8:11], s96 offen offset:3072 sc1
  s_add_u32 s96, s96, 4096
  buffer_load_dwordx4 a[164:167], v1, s[8:11], s96 offen offset:0 sc1
  v_exp_f32 v196, v196
  v_exp_f32 v197, v197
  v_exp_f32 v198, v198
  v_exp_f32 v199, v199
  v_cvt_pk_bf16_f32 v210, v196, v197
  v_cvt_pk_bf16_f32 v211, v198, v199
  s_waitcnt vmcnt(25)
  v_mfma_f32_32x32x16_bf16 v[176:191], a[36:39], v[20:23], v[176:191]
  v_exp_f32 v200, v200
  v_exp_f32 v201, v201
  v_exp_f32 v202, v202
  v_exp_f32 v203, v203
  v_cvt_pk_bf16_f32 v212, v200, v201
  v_cvt_pk_bf16_f32 v213, v202, v203
  v_mfma_f32_32x32x16_bf16 v[160:175], a[24:27], v[208:211], v[160:175]
  v_exp_f32 v204, v204
  v_exp_f32 v205, v205
  v_exp_f32 v206, v206
  v_exp_f32 v207, v207
  v_cvt_pk_bf16_f32 v214, v204, v205
  v_cvt_pk_bf16_f32 v215, v206, v207
  v_exp_f32 v176, v176
  v_exp_f32 v177, v177
  v_mfma_f32_32x32x16_bf16 v[160:175], a[28:31], v[212:215], v[160:175]
  v_exp_f32 v178, v178
  v_exp_f32 v179, v179
  v_cvt_pk_bf16_f32 v208, v176, v177
  v_cvt_pk_bf16_f32 v209, v178, v179
  v_mfma_f32_32x32x16_bf16 v[192:207], a[32:35], v[24:27], v[64:79]
  buffer_load_dwordx4 a[172:175], v1, s[8:11], s96 offen offset:1024 sc1
  v_exp_f32 v180, v180
  v_exp_f32 v181, v181
  v_exp_f32 v182, v182
  v_exp_f32 v183, v183
  v_cvt_pk_bf16_f32 v210, v180, v181
  v_cvt_pk_bf16_f32 v211, v182, v183
  v_mfma_f32_32x32x16_bf16 v[192:207], a[36:39], v[28:31], v[192:207]
  v_exp_f32 v184, v184
  v_exp_f32 v185, v185
  v_exp_f32 v186, v186
  v_exp_f32 v187, v187
  v_cvt_pk_bf16_f32 v212, v184, v185
  v_cvt_pk_bf16_f32 v213, v186, v187
  s_waitcnt vmcnt(25)
  v_mfma_f32_32x32x16_bf16 v[112:127], a[40:43], v[208:211], v[112:127]
  v_exp_f32 v188, v188
  v_exp_f32 v189, v189
  v_exp_f32 v190, v190
  v_exp_f32 v191, v191
  v_cvt_pk_bf16_f32 v214, v188, v189
  v_cvt_pk_bf16_f32 v215, v190, v191
  v_exp_f32 v192, v192
  v_exp_f32 v193, v193
  s_waitcnt vmcnt(24)
  v_mfma_f32_32x32x16_bf16 v[112:127], a[44:47], v[212:215], v[112:127]
  v_exp_f32 v194, v194
  v_exp_f32 v195, v195
  v_cvt_pk_bf16_f32 v208, v192, v193
  v_cvt_pk_bf16_f32 v209, v194, v195
  v_mfma_f32_32x32x16_bf16 v[176:191], a[32:35], v[32:35], v[80:95]
  buffer_load_dwordx4 a[180:183], v1, s[8:11], s96 offen offset:2048 sc1
  buffer_load_dwordx4 a[188:191], v1, s[8:11], s96 offen offset:3072 sc1
  v_exp_f32 v196, v196
  v_exp_f32 v197, v197
  v_exp_f32 v198, v198
  v_exp_f32 v199, v199
  v_cvt_pk_bf16_f32 v210, v196, v197
  v_cvt_pk_bf16_f32 v211, v198, v199
  v_mfma_f32_32x32x16_bf16 v[176:191], a[36:39], v[36:39], v[176:191]
  v_exp_f32 v200, v200
  v_exp_f32 v201, v201
  v_exp_f32 v202, v202
  v_exp_f32 v203, v203
  v_cvt_pk_bf16_f32 v212, v200, v201
  v_cvt_pk_bf16_f32 v213, v202, v203
  v_mfma_f32_32x32x16_bf16 v[128:143], a[40:43], v[208:211], v[128:143]
  v_exp_f32 v204, v204
  v_exp_f32 v205, v205
  v_exp_f32 v206, v206
  v_exp_f32 v207, v207
  v_cvt_pk_bf16_f32 v214, v204, v205
  v_cvt_pk_bf16_f32 v215, v206, v207
  v_exp_f32 v176, v176
  v_exp_f32 v177, v177
  v_mfma_f32_32x32x16_bf16 v[128:143], a[44:47], v[212:215], v[128:143]
  v_exp_f32 v178, v178
  v_exp_f32 v179, v179
  v_cvt_pk_bf16_f32 v208, v176, v177
  v_cvt_pk_bf16_f32 v209, v178, v179
  v_mfma_f32_32x32x16_bf16 v[192:207], a[32:35], v[40:43], v[96:111]
  s_add_u32 s96, s96, 4096
  buffer_load_dwordx4 a[196:199], v1, s[8:11], s96 offen offset:0 sc1
  buffer_load_dwordx4 a[204:207], v1, s[8:11], s96 offen offset:1024 sc1
  v_exp_f32 v180, v180
  v_exp_f32 v181, v181
  v_exp_f32 v182, v182
  v_exp_f32 v183, v183
  v_cvt_pk_bf16_f32 v210, v180, v181
  v_cvt_pk_bf16_f32 v211, v182, v183
  v_mfma_f32_32x32x16_bf16 v[192:207], a[36:39], v[44:47], v[192:207]
  v_exp_f32 v184, v184
  v_exp_f32 v185, v185
  v_exp_f32 v186, v186
  v_exp_f32 v187, v187
  v_cvt_pk_bf16_f32 v212, v184, v185
  v_cvt_pk_bf16_f32 v213, v186, v187
  v_mfma_f32_32x32x16_bf16 v[144:159], a[40:43], v[208:211], v[144:159]
  v_exp_f32 v188, v188
  v_exp_f32 v189, v189
  v_exp_f32 v190, v190
  v_exp_f32 v191, v191
  v_cvt_pk_bf16_f32 v214, v188, v189
  v_cvt_pk_bf16_f32 v215, v190, v191
  v_exp_f32 v192, v192
  v_exp_f32 v193, v193
  v_mfma_f32_32x32x16_bf16 v[144:159], a[44:47], v[212:215], v[144:159]
  v_exp_f32 v194, v194
  v_exp_f32 v195, v195
  v_cvt_pk_bf16_f32 v208, v192, v193
  v_cvt_pk_bf16_f32 v209, v194, v195
  s_waitcnt vmcnt(20)
  v_mfma_f32_32x32x16_bf16 v[176:191], a[48:51], v[16:19], v[48:63]
  buffer_load_dwordx4 a[212:215], v1, s[8:11], s96 offen offset:2048 sc1
  v_exp_f32 v196, v196
  v_exp_f32 v197, v197
  v_exp_f32 v198, v198
  v_exp_f32 v199, v199
  v_cvt_pk_bf16_f32 v210, v196, v197
  v_cvt_pk_bf16_f32 v211, v198, v199
  s_waitcnt vmcnt(20)
  v_mfma_f32_32x32x16_bf16 v[176:191], a[52:55], v[20:23], v[176:191]
  v_exp_f32 v200, v200
  v_exp_f32 v201, v201
  v_exp_f32 v202, v202
  v_exp_f32 v203, v203
  v_cvt_pk_bf16_f32 v212, v200, v201
  v_cvt_pk_bf16_f32 v213, v202, v203
  v_mfma_f32_32x32x16_bf16 v[160:175], a[40:43], v[208:211], v[160:175]
  v_exp_f32 v204, v204
  v_exp_f32 v205, v205
  v_exp_f32 v206, v206
  v_exp_f32 v207, v207
  v_cvt_pk_bf16_f32 v214, v204, v205
  v_cvt_pk_bf16_f32 v215, v206, v207
  v_exp_f32 v176, v176
  v_exp_f32 v177, v177
  v_mfma_f32_32x32x16_bf16 v[160:175], a[44:47], v[212:215], v[160:175]
  v_exp_f32 v178, v178
  v_exp_f32 v179, v179
  v_cvt_pk_bf16_f32 v208, v176, v177
  v_cvt_pk_bf16_f32 v209, v178, v179
  v_mfma_f32_32x32x16_bf16 v[192:207], a[48:51], v[24:27], v[64:79]
  buffer_load_dwordx4 a[220:223], v1, s[8:11], s96 offen offset:3072 sc1
  s_add_u32 s96, s96, 4096
  buffer_load_dwordx4 a[228:231], v1, s[8:11], s96 offen offset:0 sc1
  v_exp_f32 v180, v180
  v_exp_f32 v181, v181
  v_exp_f32 v182, v182
  v_exp_f32 v183, v183
  v_cvt_pk_bf16_f32 v210, v180, v181
  v_cvt_pk_bf16_f32 v211, v182, v183
  v_mfma_f32_32x32x16_bf16 v[192:207], a[52:55], v[28:31], v[192:207]
  v_exp_f32 v184, v184
  v_exp_f32 v185, v185
  v_exp_f32 v186, v186
  v_exp_f32 v187, v187
  v_cvt_pk_bf16_f32 v212, v184, v185
  v_cvt_pk_bf16_f32 v213, v186, v187
  s_waitcnt vmcnt(21)
  v_mfma_f32_32x32x16_bf16 v[112:127], a[56:59], v[208:211], v[112:127]
  v_exp_f32 v188, v188
  v_exp_f32 v189, v189
  v_exp_f32 v190, v190
  v_exp_f32 v191, v191
  v_cvt_pk_bf16_f32 v214, v188, v189
  v_cvt_pk_bf16_f32 v215, v190, v191
  v_exp_f32 v192, v192
  v_exp_f32 v193, v193
  s_waitcnt vmcnt(20)
  v_mfma_f32_32x32x16_bf16 v[112:127], a[60:63], v[212:215], v[112:127]
  v_exp_f32 v194, v194
  v_exp_f32 v195, v195
  v_cvt_pk_bf16_f32 v208, v192, v193
  v_cvt_pk_bf16_f32 v209, v194, v195
  v_mfma_f32_32x32x16_bf16 v[176:191], a[48:51], v[32:35], v[80:95]
  buffer_load_dwordx4 a[236:239], v1, s[8:11], s96 offen offset:1024 sc1
  buffer_load_dwordx4 a[244:247], v1, s[8:11], s96 offen offset:2048 sc1
  v_exp_f32 v196, v196
  v_exp_f32 v197, v197
  v_exp_f32 v198, v198
  v_exp_f32 v199, v199
  v_cvt_pk_bf16_f32 v210, v196, v197
  v_cvt_pk_bf16_f32 v211, v198, v199
  v_mfma_f32_32x32x16_bf16 v[176:191], a[52:55], v[36:39], v[176:191]
  v_exp_f32 v200, v200
  v_exp_f32 v201, v201
  v_exp_f32 v202, v202
  v_exp_f32 v203, v203
  v_cvt_pk_bf16_f32 v212, v200, v201
  v_cvt_pk_bf16_f32 v213, v202, v203
  v_mfma_f32_32x32x16_bf16 v[128:143], a[56:59], v[208:211], v[128:143]
  v_exp_f32 v204, v204
  v_exp_f32 v205, v205
  v_exp_f32 v206, v206
  v_exp_f32 v207, v207
  v_cvt_pk_bf16_f32 v214, v204, v205
  v_cvt_pk_bf16_f32 v215, v206, v207
  v_exp_f32 v176, v176
  v_exp_f32 v177, v177
  v_mfma_f32_32x32x16_bf16 v[128:143], a[60:63], v[212:215], v[128:143]
  v_exp_f32 v178, v178
  v_exp_f32 v179, v179
  v_cvt_pk_bf16_f32 v208, v176, v177
  v_cvt_pk_bf16_f32 v209, v178, v179
  v_mfma_f32_32x32x16_bf16 v[192:207], a[48:51], v[40:43], v[96:111]
  buffer_load_dwordx4 a[252:255], v1, s[8:11], s96 offen offset:3072 sc1
  v_exp_f32 v180, v180
  v_exp_f32 v181, v181
  v_exp_f32 v182, v182
  v_exp_f32 v183, v183
  v_cvt_pk_bf16_f32 v210, v180, v181
  v_cvt_pk_bf16_f32 v211, v182, v183
  v_mfma_f32_32x32x16_bf16 v[192:207], a[52:55], v[44:47], v[192:207]
  v_exp_f32 v184, v184
  v_exp_f32 v185, v185
  v_exp_f32 v186, v186
  v_exp_f32 v187, v187
  v_cvt_pk_bf16_f32 v212, v184, v185
  v_cvt_pk_bf16_f32 v213, v186, v187
  v_mfma_f32_32x32x16_bf16 v[144:159], a[56:59], v[208:211], v[144:159]
  v_exp_f32 v188, v188
  v_exp_f32 v189, v189
  v_exp_f32 v190, v190
  v_exp_f32 v191, v191
  v_cvt_pk_bf16_f32 v214, v188, v189
  v_cvt_pk_bf16_f32 v215, v190, v191
  v_exp_f32 v192, v192
  v_exp_f32 v193, v193
  v_mfma_f32_32x32x16_bf16 v[144:159], a[60:63], v[212:215], v[144:159]
  v_exp_f32 v194, v194
  v_exp_f32 v195, v195
  v_cvt_pk_bf16_f32 v208, v192, v193
  v_cvt_pk_bf16_f32 v209, v194, v195
  v_exp_f32 v196, v196
  v_exp_f32 v197, v197
  v_exp_f32 v198, v198
  v_exp_f32 v199, v199
  v_cvt_pk_bf16_f32 v210, v196, v197
  v_cvt_pk_bf16_f32 v211, v198, v199
  v_exp_f32 v200, v200
  v_exp_f32 v201, v201
  v_exp_f32 v202, v202
  v_exp_f32 v203, v203
  v_cvt_pk_bf16_f32 v212, v200, v201
  v_cvt_pk_bf16_f32 v213, v202, v203
  v_mfma_f32_32x32x16_bf16 v[160:175], a[56:59], v[208:211], v[160:175]
  v_exp_f32 v204, v204
  v_exp_f32 v205, v205
  v_exp_f32 v206, v206
  v_exp_f32 v207, v207
  v_cvt_pk_bf16_f32 v214, v204, v205
  v_cvt_pk_bf16_f32 v215, v206, v207
  s_nop 1
  v_mfma_f32_32x32x16_bf16 v[160:175], a[60:63], v[212:215], v[160:175]
  v_mov_b32 v224, 0x5f800000
  s_mov_b64 s[40:41], -1
  v_cmp_lt_f32 vcc, v124, v224
  s_nop 0
  s_and_b64 s[40:41], s[40:41], vcc
  v_cmp_lt_f32 vcc, v140, v224
  s_nop 0
  s_and_b64 s[40:41], s[40:41], vcc
  v_cmp_lt_f32 vcc, v156, v224
  s_nop 0
  s_and_b64 s[40:41], s[40:41], vcc
  s_nop 0
  v_cmp_lt_f32 vcc, v172, v224
  s_nop 0
  s_and_b64 s[40:41], s[40:41], vcc
  s_cmp_eq_u32 s41, -1
  s_cbranch_scc1 L_att_ok_53
  s_cmp_lg_u32 s38, 0
  s_cbranch_scc1 L_att_ok_53
  s_mov_b32 s38, 1
  s_waitcnt vmcnt(0)
  s_branch L_att_re_52
L_att_ok_53:
  s_xor_b32 s40, s3, 1
  s_mul_i32 s40, s40, 3
  s_add_u32 s40, s40, 0
  s_lshl_b32 s41, s40, 12
  v_add_u32 v224, s41, v1
  ds_write_b128 v224, v[128:131] offset:0
  ds_write_b128 v224, v[132:135] offset:1024
  ds_write_b128 v224, v[136:139] offset:2048
  ds_write_b128 v224, v[140:143] offset:3072
  s_lshl_b32 s41, s40, 8
  v_lshl_add_u32 v225, v2, 2, s41
  ds_write_b32 v225, v242 offset:49152
  s_xor_b32 s40, s3, 2
  s_mul_i32 s40, s40, 3
  s_add_u32 s40, s40, 1
  s_lshl_b32 s41, s40, 12
  v_add_u32 v224, s41, v1
  ds_write_b128 v224, v[144:147] offset:0
  ds_write_b128 v224, v[148:151] offset:1024
  ds_write_b128 v224, v[152:155] offset:2048
  ds_write_b128 v224, v[156:159] offset:3072
  s_lshl_b32 s41, s40, 8
  v_lshl_add_u32 v225, v2, 2, s41
  ds_write_b32 v225, v243 offset:49152
  s_xor_b32 s40, s3, 3
  s_mul_i32 s40, s40, 3
  s_add_u32 s40, s40, 2
  s_lshl_b32 s41, s40, 12
  v_add_u32 v224, s41, v1
  ds_write_b128 v224, v[160:163] offset:0
  ds_write_b128 v224, v[164:167] offset:1024
  ds_write_b128 v224, v[168:171] offset:2048
  ds_write_b128 v224, v[172:175] offset:3072
  s_lshl_b32 s41, s40, 8
  v_lshl_add_u32 v225, v2, 2, s41
  ds_write_b32 v225, v244 offset:49152
  s_waitcnt lgkmcnt(0)
  s_barrier
  s_mul_i32 s40, s3, 3
  s_lshl_b32 s41, s40, 12
  v_add_u32 v224, s41, v1
  s_lshl_b32 s41, s40, 8
  v_lshl_add_u32 v225, v2, 2, s41
  ds_read_b32 v226, v225 offset:49152
  ds_read_b32 v227, v225 offset:49408
  ds_read_b32 v228, v225 offset:49664
  ds_read_b128 v[48:51], v224 offset:0
  ds_read_b128 v[52:55], v224 offset:1024
  ds_read_b128 v[56:59], v224 offset:2048
  ds_read_b128 v[60:63], v224 offset:3072
  ds_read_b128 v[64:67], v224 offset:4096
  ds_read_b128 v[68:71], v224 offset:5120
  ds_read_b128 v[72:75], v224 offset:6144
  ds_read_b128 v[76:79], v224 offset:7168
  ds_read_b128 v[80:83], v224 offset:8192
  ds_read_b128 v[84:87], v224 offset:9216
  ds_read_b128 v[88:91], v224 offset:10240
  ds_read_b128 v[92:95], v224 offset:11264
  s_waitcnt lgkmcnt(12)
  v_max3_f32 v229, v226, v227, v228
  v_max_f32 v229, v229, v241
  v_sub_f32 v230, v241, v229
  v_sub_f32 v226, v226, v229
  v_sub_f32 v227, v227, v229
  v_sub_f32 v228, v228, v229
  v_exp_f32 v230, v230
  v_exp_f32 v226, v226
  v_exp_f32 v227, v227
  v_exp_f32 v228, v228
  v_pk_mul_f32 v[112:113], v[112:113], v[230:231] op_sel:[0,0] op_sel_hi:[1,0]
  v_pk_mul_f32 v[114:115], v[114:115], v[230:231] op_sel:[0,0] op_sel_hi:[1,0]
  v_pk_mul_f32 v[116:117], v[116:117], v[230:231] op_sel:[0,0] op_sel_hi:[1,0]
  v_pk_mul_f32 v[118:119], v[118:119], v[230:231] op_sel:[0,0] op_sel_hi:[1,0]
  v_pk_mul_f32 v[120:121], v[120:121], v[230:231] op_sel:[0,0] op_sel_hi:[1,0]
  v_pk_mul_f32 v[122:123], v[122:123], v[230:231] op_sel:[0,0] op_sel_hi:[1,0]
  v_pk_mul_f32 v[124:125], v[124:125], v[230:231] op_sel:[0,0] op_sel_hi:[1,0]
  v_pk_mul_f32 v[126:127], v[126:127], v[230:231] op_sel:[0,0] op_sel_hi:[1,0]
  s_waitcnt lgkmcnt(11)
  v_pk_fma_f32 v[112:113], v[48:49], v[226:227], v[112:113] op_sel:[0,0,0] op_sel_hi:[1,0,1]
  v_pk_fma_f32 v[114:115], v[50:51], v[226:227], v[114:115] op_sel:[0,0,0] op_sel_hi:[1,0,1]
  s_waitcnt lgkmcnt(10)
  v_pk_fma_f32 v[116:117], v[52:53], v[226:227], v[116:117] op_sel:[0,0,0] op_sel_hi:[1,0,1]
  v_pk_fma_f32 v[118:119], v[54:55], v[226:227], v[118:119] op_sel:[0,0,0] op_sel_hi:[1,0,1]
  s_waitcnt lgkmcnt(9)
  v_pk_fma_f32 v[120:121], v[56:57], v[226:227], v[120:121] op_sel:[0,0,0] op_sel_hi:[1,0,1]
  v_pk_fma_f32 v[122:123], v[58:59], v[226:227], v[122:123] op_sel:[0,0,0] op_sel_hi:[1,0,1]
  s_waitcnt lgkmcnt(8)
  v_pk_fma_f32 v[124:125], v[60:61], v[226:227], v[124:125] op_sel:[0,0,0] op_sel_hi:[1,0,1]
  v_pk_fma_f32 v[126:127], v[62:63], v[226:227], v[126:127] op_sel:[0,0,0] op_sel_hi:[1,0,1]
  s_waitcnt lgkmcnt(7)
  v_pk_fma_f32 v[112:113], v[64:65], v[226:227], v[112:113] op_sel:[0,1,0] op_sel_hi:[1,1,1]
  v_pk_fma_f32 v[114:115], v[66:67], v[226:227], v[114:115] op_sel:[0,1,0] op_sel_hi:[1,1,1]
  s_waitcnt lgkmcnt(6)
  v_pk_fma_f32 v[116:117], v[68:69], v[226:227], v[116:117] op_sel:[0,1,0] op_sel_hi:[1,1,1]
  v_pk_fma_f32 v[118:119], v[70:71], v[226:227], v[118:119] op_sel:[0,1,0] op_sel_hi:[1,1,1]
  s_waitcnt lgkmcnt(5)
  v_pk_fma_f32 v[120:121], v[72:73], v[226:227], v[120:121] op_sel:[0,1,0] op_sel_hi:[1,1,1]
  v_pk_fma_f32 v[122:123], v[74:75], v[226:227], v[122:123] op_sel:[0,1,0] op_sel_hi:[1,1,1]
  s_waitcnt lgkmcnt(4)
  v_pk_fma_f32 v[124:125], v[76:77], v[226:227], v[124:125] op_sel:[0,1,0] op_sel_hi:[1,1,1]
  v_pk_fma_f32 v[126:127], v[78:79], v[226:227], v[126:127] op_sel:[0,1,0] op_sel_hi:[1,1,1]
  s_waitcnt lgkmcnt(3)
  v_pk_fma_f32 v[112:113], v[80:81], v[228:229], v[112:113] op_sel:[0,0,0] op_sel_hi:[1,0,1]
  v_pk_fma_f32 v[114:115], v[82:83], v[228:229], v[114:115] op_sel:[0,0,0] op_sel_hi:[1,0,1]
  s_waitcnt lgkmcnt(2)
  v_pk_fma_f32 v[116:117], v[84:85], v[228:229], v[116:117] op_sel:[0,0,0] op_sel_hi:[1,0,1]
  v_pk_fma_f32 v[118:119], v[86:87], v[228:229], v[118:119] op_sel:[0,0,0] op_sel_hi:[1,0,1]
  s_waitcnt lgkmcnt(1)
  v_pk_fma_f32 v[120:121], v[88:89], v[228:229], v[120:121] op_sel:[0,0,0] op_sel_hi:[1,0,1]
  v_pk_fma_f32 v[122:123], v[90:91], v[228:229], v[122:123] op_sel:[0,0,0] op_sel_hi:[1,0,1]
  s_waitcnt lgkmcnt(0)
  v_pk_fma_f32 v[124:125], v[92:93], v[228:229], v[124:125] op_sel:[0,0,0] op_sel_hi:[1,0,1]
  v_pk_fma_f32 v[126:127], v[94:95], v[228:229], v[126:127] op_sel:[0,0,0] op_sel_hi:[1,0,1]
  v_mov_b32 v231, v124
  v_mov_b32 v232, v124
  s_nop 1
  v_permlane32_swap_b32 v231, v232
  v_rcp_f32 v232, v232
  s_nop 0
  v_pk_mul_f32 v[112:113], v[112:113], v[232:233] op_sel:[0,0] op_sel_hi:[1,0]
  v_pk_mul_f32 v[114:115], v[114:115], v[232:233] op_sel:[0,0] op_sel_hi:[1,0]
  v_pk_mul_f32 v[116:117], v[116:117], v[232:233] op_sel:[0,0] op_sel_hi:[1,0]
  v_pk_mul_f32 v[118:119], v[118:119], v[232:233] op_sel:[0,0] op_sel_hi:[1,0]
  v_pk_mul_f32 v[120:121], v[120:121], v[232:233] op_sel:[0,0] op_sel_hi:[1,0]
  v_pk_mul_f32 v[122:123], v[122:123], v[232:233] op_sel:[0,0] op_sel_hi:[1,0]
  v_pk_mul_f32 v[124:125], v[124:125], v[232:233] op_sel:[0,0] op_sel_hi:[1,0]
  v_pk_mul_f32 v[126:127], v[126:127], v[232:233] op_sel:[0,0] op_sel_hi:[1,0]
  v_cvt_pk_bf16_f32 v208, v112, v113
  v_cvt_pk_bf16_f32 v209, v114, v115
  v_cvt_pk_bf16_f32 v210, v116, v117
  v_cvt_pk_bf16_f32 v211, v118, v119
  v_cvt_pk_bf16_f32 v212, v120, v121
  v_cvt_pk_bf16_f32 v213, v122, v123
  v_cvt_pk_bf16_f32 v214, v124, v125
  v_cvt_pk_bf16_f32 v215, v126, v127
  s_lshl_b32 s40, s79, 2
  s_add_u32 s40, s40, s3
  s_lshl_b32 s40, s40, 5
  s_lshl_b32 s41, s78, 1
  s_add_u32 s40, s40, s41
  s_lshl_b32 s40, s40, 10
  s_add_u32 s40, s40, s68
  s_add_u32 s40, s40, 6291456
  buffer_store_dwordx4 v[208:211], v1, s[8:11], s40 offen offset:0 sc1
  buffer_store_dwordx4 v[212:215], v1, s[8:11], s40 offen offset:1024 sc1
  s_lshl_b32 s34, s79, 7
  s_add_u32 s34, s34, s84
  s_lshl_b32 s35, s78, 2
  s_add_u32 s34, s34, s35
  s_add_u32 s34, s34, 4096
  s_waitcnt vmcnt(0) lgkmcnt(0)
  s_barrier
  s_cmp_lg_u32 s3, 0
  s_cbranch_scc1 L_sig_58
  v_mov_b32 v4, s34
  s_mov_b64 exec, 1
  buffer_store_dword v3, v4, s[8:11], 0 offen sc1
  s_mov_b64 exec, -1
L_sig_58:
  s_cmp_ge_u32 s5, 28
  s_cbranch_scc1 L_skip
  s_and_b32 s32, s3, 1
  s_lshr_b32 s33, s3, 1
  s_lshl_b32 s36, s80, 1
  s_add_u32 s36, s36, s33
  s_lshl_b32 s37, s81, 1
  s_add_u32 s37, s37, s32
  s_mul_i32 s38, s36, 28
  s_lshl_b32 s39, s37, 1
  s_add_u32 s38, s38, s39
  s_lshl_b32 s38, s38, 10
  s_lshl_b32 s39, s6, 1
  s_mul_i32 s40, s39, 1835008
  s_add_u32 s40, s40, s38
  s_add_u32 s40, s40, 6135808
  s_cmp_eq_u32 s6, 0
  s_cbranch_scc1 L_ra_59
  buffer_load_dwordx4 v[10:13], v1, s[8:11], s40 offen offset:0 sc1
  buffer_load_dwordx4 v[14:17], v1, s[8:11], s40 offen offset:1024 sc1
  s_branch L_rb_60
L_ra_59:
  v_and_b32 v4, 31, v2
  v_mul_u32_u24 v4, 896, v4
  v_lshrrev_b32 v7, 5, v2
  v_lshl_add_u32 v4, v7, 4, v4
  s_mul_i32 s41, s36, 28672
  s_lshl_b32 s42, s37, 6
  s_add_u32 s41, s41, s42
  buffer_load_dwordx4 v[10:13], v4, s[24:27], s41 offen offset:0
  buffer_load_dwordx4 v[14:17], v4, s[24:27], s41 offen offset:32
L_rb_60:
  s_lshr_b32 s41, s80, 1
  s_lshl_b32 s41, s41, 7
  s_add_u32 s41, s41, s84
  s_add_u32 s41, s41, 4096
  s_cmp_lg_u32 s3, 0
  s_cbranch_scc1 L_wd_62
  s_cmp_lg_u32 s60, 0
  s_cbranch_scc1 L_wd_62
  v_lshlrev_b32 v4, 2, v2
  v_add_u32 v4, s41, v4
  s_mov_b32 exec_lo, 0x0000ffff
  s_mov_b32 exec_hi, 0x00000000
  s_mov_b32 s58, 0
L_poll_63:
  buffer_load_dword v7, v4, s[8:11], 0 offen sc1
  s_waitcnt vmcnt(0)
  v_cmp_eq_u32 vcc, 1, v7
  s_add_u32 s58, s58, 1
  s_cmp_eq_u64 vcc, exec
  s_cbranch_scc1 L_wd_62_d
  s_cmp_lt_u32 s58, 60000
  s_cbranch_scc1 L_poll_63
  s_or_b32 s60, s60, 1
L_wd_62_d:
  s_mov_b64 exec, -1
L_wd_62:
  s_barrier
  v_and_b32 v18, 31, v2
  v_lshlrev_b32 v18, 2, v18
  s_lshl_b32 s34, s4, 7
  s_add_u32 s34, s34, 32768
  buffer_load_dword v19, v18, s[8:11], s34 offen sc1
  s_xor_b32 s34, s33, 0
  s_lshl_b32 s35, s80, 1
  s_add_u32 s34, s34, s35
  s_mul_i32 s34, s34, 32
  s_mul_i32 s35, s3, 8
  s_add_u32 s34, s34, s35
  s_lshl_b32 s34, s34, 10
  s_add_u32 s34, s34, s68
  s_add_u32 s44, s34, 6291456
  s_xor_b32 s34, s33, 1
  s_lshl_b32 s35, s80, 1
  s_add_u32 s34, s34, s35
  s_mul_i32 s34, s34, 32
  s_mul_i32 s35, s3, 8
  s_add_u32 s34, s34, s35
  s_lshl_b32 s34, s34, 10
  s_add_u32 s34, s34, s68
  s_add_u32 s45, s34, 6291456
  s_add_u32 s46, s44, 0
  buffer_load_dwordx4 v[32:35], v1, s[8:11], s46 offen offset:0 sc1
  s_add_u32 s47, s45, 0
  buffer_load_dwordx4 v[36:39], v1, s[8:11], s47 offen offset:0 sc1
  buffer_load_dwordx4 v[40:43], v1, s[8:11], s46 offen offset:1024 sc1
  buffer_load_dwordx4 v[44:47], v1, s[8:11], s47 offen offset:1024 sc1
  buffer_load_dwordx4 v[48:51], v1, s[8:11], s46 offen offset:2048 sc1
  buffer_load_dwordx4 v[52:55], v1, s[8:11], s47 offen offset:2048 sc1
  buffer_load_dwordx4 v[56:59], v1, s[8:11], s46 offen offset:3072 sc1
  buffer_load_dwordx4 v[60:63], v1, s[8:11], s47 offen offset:3072 sc1
  s_add_u32 s46, s44, 4096
  buffer_load_dwordx4 v[64:67], v1, s[8:11], s46 offen offset:0 sc1
  s_add_u32 s47, s45, 4096
  buffer_load_dwordx4 v[68:71], v1, s[8:11], s47 offen offset:0 sc1
  s_waitcnt vmcnt(9)
  v_mfma_f32_32x32x16_bf16 v[192:207], a[64:67], v[32:35], 0
  v_mfma_f32_32x32x16_bf16 v[208:223], a[96:99], v[32:35], 0
  s_waitcnt vmcnt(8)
  v_mfma_f32_32x32x16_bf16 v[224:239], a[64:67], v[36:39], 0
  v_mfma_f32_32x32x16_bf16 v[240:255], a[96:99], v[36:39], 0
  buffer_load_dwordx4 v[72:75], v1, s[8:11], s46 offen offset:1024 sc1
  buffer_load_dwordx4 v[76:79], v1, s[8:11], s47 offen offset:1024 sc1
  s_waitcnt vmcnt(9)
  v_mfma_f32_32x32x16_bf16 v[192:207], a[68:71], v[40:43], v[192:207]
  v_mfma_f32_32x32x16_bf16 v[208:223], a[100:103], v[40:43], v[208:223]
  s_waitcnt vmcnt(8)
  v_mfma_f32_32x32x16_bf16 v[224:239], a[68:71], v[44:47], v[224:239]
  v_mfma_f32_32x32x16_bf16 v[240:255], a[100:103], v[44:47], v[240:255]
  buffer_load_dwordx4 v[80:83], v1, s[8:11], s46 offen offset:2048 sc1
  buffer_load_dwordx4 v[84:87], v1, s[8:11], s47 offen offset:2048 sc1
  s_waitcnt vmcnt(9)
  v_mfma_f32_32x32x16_bf16 v[192:207], a[72:75], v[48:51], v[192:207]
  v_mfma_f32_32x32x16_bf16 v[208:223], a[104:107], v[48:51], v[208:223]
  s_waitcnt vmcnt(8)
  v_mfma_f32_32x32x16_bf16 v[224:239], a[72:75], v[52:55], v[224:239]
  v_mfma_f32_32x32x16_bf16 v[240:255], a[104:107], v[52:55], v[240:255]
  buffer_load_dwordx4 v[88:91], v1, s[8:11], s46 offen offset:3072 sc1
  buffer_load_dwordx4 v[92:95], v1, s[8:11], s47 offen offset:3072 sc1
  s_waitcnt vmcnt(9)
  v_mfma_f32_32x32x16_bf16 v[192:207], a[76:79], v[56:59], v[192:207]
  v_mfma_f32_32x32x16_bf16 v[208:223], a[108:111], v[56:59], v[208:223]
  s_waitcnt vmcnt(8)
  v_mfma_f32_32x32x16_bf16 v[224:239], a[76:79], v[60:63], v[224:239]
  v_mfma_f32_32x32x16_bf16 v[240:255], a[108:111], v[60:63], v[240:255]
  s_waitcnt vmcnt(7)
  v_mfma_f32_32x32x16_bf16 v[192:207], a[80:83], v[64:67], v[192:207]
  v_mfma_f32_32x32x16_bf16 v[208:223], a[112:115], v[64:67], v[208:223]
  s_waitcnt vmcnt(6)
  v_mfma_f32_32x32x16_bf16 v[224:239], a[80:83], v[68:71], v[224:239]
  v_mfma_f32_32x32x16_bf16 v[240:255], a[112:115], v[68:71], v[240:255]
  s_waitcnt vmcnt(5)
  v_mfma_f32_32x32x16_bf16 v[192:207], a[84:87], v[72:75], v[192:207]
  v_mfma_f32_32x32x16_bf16 v[208:223], a[116:119], v[72:75], v[208:223]
  s_waitcnt vmcnt(4)
  v_mfma_f32_32x32x16_bf16 v[224:239], a[84:87], v[76:79], v[224:239]
  v_mfma_f32_32x32x16_bf16 v[240:255], a[116:119], v[76:79], v[240:255]
  s_waitcnt vmcnt(3)
  v_mfma_f32_32x32x16_bf16 v[192:207], a[88:91], v[80:83], v[192:207]
  v_mfma_f32_32x32x16_bf16 v[208:223], a[120:123], v[80:83], v[208:223]
  s_waitcnt vmcnt(2)
  v_mfma_f32_32x32x16_bf16 v[224:239], a[88:91], v[84:87], v[224:239]
  v_mfma_f32_32x32x16_bf16 v[240:255], a[120:123], v[84:87], v[240:255]
  s_waitcnt vmcnt(1)
  v_mfma_f32_32x32x16_bf16 v[192:207], a[92:95], v[88:91], v[192:207]
  v_mfma_f32_32x32x16_bf16 v[208:223], a[124:127], v[88:91], v[208:223]
  s_waitcnt vmcnt(0)
  v_mfma_f32_32x32x16_bf16 v[224:239], a[92:95], v[92:95], v[224:239]
  v_mfma_f32_32x32x16_bf16 v[240:255], a[124:127], v[92:95], v[240:255]
  v_cmp_eq_u32 vcc, s59, v19
  s_nop 0
  s_cmp_eq_u64 vcc, -1
  s_cselect_b32 s14, 0, 0x10000000
  s_cselect_b32 s94, 0x10000000, 0
  s_xor_b32 s46, s3, 1
  s_mul_i32 s46, s46, 3
  s_add_u32 s46, s46, 0
  s_lshl_b32 s46, s46, 12
  v_add_u32 v20, s46, v1
  ds_write_b128 v20, v[208:211] offset:0
  ds_write_b128 v20, v[212:215] offset:1024
  ds_write_b128 v20, v[216:219] offset:2048
  ds_write_b128 v20, v[220:223] offset:3072
  s_xor_b32 s46, s3, 2
  s_mul_i32 s46, s46, 3
  s_add_u32 s46, s46, 1
  s_lshl_b32 s46, s46, 12
  v_add_u32 v20, s46, v1
  ds_write_b128 v20, v[224:227] offset:0
  ds_write_b128 v20, v[228:231] offset:1024
  ds_write_b128 v20, v[232:235] offset:2048
  ds_write_b128 v20, v[236:239] offset:3072
  s_xor_b32 s46, s3, 3
  s_mul_i32 s46, s46, 3
  s_add_u32 s46, s46, 2
  s_lshl_b32 s46, s46, 12
  v_add_u32 v20, s46, v1
  ds_write_b128 v20, v[240:243] offset:0
  ds_write_b128 v20, v[244:247] offset:1024
  ds_write_b128 v20, v[248:251] offset:2048
  ds_write_b128 v20, v[252:255] offset:3072
  v_lshlrev_b32 v32, 16, v10
  v_and_b32 v33, 0xffff0000, v10
  v_lshlrev_b32 v34, 16, v11
  v_and_b32 v35, 0xffff0000, v11
  v_lshlrev_b32 v36, 16, v12
  v_and_b32 v37, 0xffff0000, v12
  v_lshlrev_b32 v38, 16, v13
  v_and_b32 v39, 0xffff0000, v13
  v_lshlrev_b32 v40, 16, v14
  v_and_b32 v41, 0xffff0000, v14
  v_lshlrev_b32 v42, 16, v15
  v_and_b32 v43, 0xffff0000, v15
  v_lshlrev_b32 v44, 16, v16
  v_and_b32 v45, 0xffff0000, v16
  v_lshlrev_b32 v46, 16, v17
  v_and_b32 v47, 0xffff0000, v17
  s_waitcnt lgkmcnt(0)
  s_barrier
  s_mul_i32 s46, s3, 12288
  v_add_u32 v20, s46, v1
  ds_read_b128 v[64:67], v20 offset:0
  ds_read_b128 v[68:71], v20 offset:1024
  ds_read_b128 v[72:75], v20 offset:2048
  ds_read_b128 v[76:79], v20 offset:3072
  ds_read_b128 v[80:83], v20 offset:4096
  ds_read_b128 v[84:87], v20 offset:5120
  ds_read_b128 v[88:91], v20 offset:6144
  ds_read_b128 v[92:95], v20 offset:7168
  ds_read_b128 v[96:99], v20 offset:8192
  ds_read_b128 v[100:103], v20 offset:9216
  ds_read_b128 v[104:107], v20 offset:10240
  ds_read_b128 v[108:111], v20 offset:11264
  s_waitcnt lgkmcnt(11)
  v_pk_add_f32 v[192:193], v[192:193], v[64:65]
  v_pk_add_f32 v[194:195], v[194:195], v[66:67]
  s_waitcnt lgkmcnt(10)
  v_pk_add_f32 v[196:197], v[196:197], v[68:69]
  v_pk_add_f32 v[198:199], v[198:199], v[70:71]
  s_waitcnt lgkmcnt(9)
  v_pk_add_f32 v[200:201], v[200:201], v[72:73]
  v_pk_add_f32 v[202:203], v[202:203], v[74:75]
  s_waitcnt lgkmcnt(8)
  v_pk_add_f32 v[204:205], v[204:205], v[76:77]
  v_pk_add_f32 v[206:207], v[206:207], v[78:79]
  s_waitcnt lgkmcnt(7)
  v_pk_add_f32 v[192:193], v[192:193], v[80:81]
  v_pk_add_f32 v[194:195], v[194:195], v[82:83]
  s_waitcnt lgkmcnt(6)
  v_pk_add_f32 v[196:197], v[196:197], v[84:85]
  v_pk_add_f32 v[198:199], v[198:199], v[86:87]
  s_waitcnt lgkmcnt(5)
  v_pk_add_f32 v[200:201], v[200:201], v[88:89]
  v_pk_add_f32 v[202:203], v[202:203], v[90:91]
  s_waitcnt lgkmcnt(4)
  v_pk_add_f32 v[204:205], v[204:205], v[92:93]
  v_pk_add_f32 v[206:207], v[206:207], v[94:95]
  s_waitcnt lgkmcnt(3)
  v_pk_add_f32 v[192:193], v[192:193], v[96:97]
  v_pk_add_f32 v[194:195], v[194:195], v[98:99]
  s_waitcnt lgkmcnt(2)
  v_pk_add_f32 v[196:197], v[196:197], v[100:101]
  v_pk_add_f32 v[198:199], v[198:199], v[102:103]
  s_waitcnt lgkmcnt(1)
  v_pk_add_f32 v[200:201], v[200:201], v[104:105]
  v_pk_add_f32 v[202:203], v[202:203], v[106:107]
  s_waitcnt lgkmcnt(0)
  v_pk_add_f32 v[204:205], v[204:205], v[108:109]
  v_pk_add_f32 v[206:207], v[206:207], v[110:111]
  v_pk_add_f32 v[192:193], v[192:193], v[32:33]
  v_pk_add_f32 v[194:195], v[194:195], v[34:35]
  v_pk_add_f32 v[196:197], v[196:197], v[36:37]
  v_pk_add_f32 v[198:199], v[198:199], v[38:39]
  v_pk_add_f32 v[200:201], v[200:201], v[40:41]
  v_pk_add_f32 v[202:203], v[202:203], v[42:43]
  v_pk_add_f32 v[204:205], v[204:205], v[44:45]
  v_pk_add_f32 v[206:207], v[206:207], v[46:47]
  v_cvt_pk_bf16_f32 v48, v192, v193
  v_cvt_pk_bf16_f32 v49, v194, v195
  v_cvt_pk_bf16_f32 v50, v196, v197
  v_cvt_pk_bf16_f32 v51, v198, v199
  v_cvt_pk_bf16_f32 v52, v200, v201
  v_cvt_pk_bf16_f32 v53, v202, v203
  v_cvt_pk_bf16_f32 v54, v204, v205
  v_cvt_pk_bf16_f32 v55, v206, v207
  s_add_u32 s40, s40, 1835008
  buffer_store_dwordx4 v[48:51], v1, s[8:11], s40 offen offset:0 sc1
  buffer_store_dwordx4 v[52:55], v1, s[8:11], s40 offen offset:1024 sc1
  s_mov_b32 s47, 0x3f803f80
  v_mov_b32 v22, 0
  v_mov_b32 v23, 0
  v_mov_b32 v24, 0
  v_mov_b32 v25, 0
  v_dot2_f32_bf16 v22, v48, s47, v22
  v_dot2_f32_bf16 v23, v48, v48, v23
  v_dot2_f32_bf16 v24, v49, s47, v24
  v_dot2_f32_bf16 v25, v49, v49, v25
  v_dot2_f32_bf16 v22, v50, s47, v22
  v_dot2_f32_bf16 v23, v50, v50, v23
  v_dot2_f32_bf16 v24, v51, s47, v24
  v_dot2_f32_bf16 v25, v51, v51, v25
  v_dot2_f32_bf16 v22, v52, s47, v22
  v_dot2_f32_bf16 v23, v52, v52, v23
  v_dot2_f32_bf16 v24, v53, s47, v24
  v_dot2_f32_bf16 v25, v53, v53, v25
  v_dot2_f32_bf16 v22, v54, s47, v22
  v_dot2_f32_bf16 v23, v54, v54, v23
  v_dot2_f32_bf16 v24, v55, s47, v24
  v_dot2_f32_bf16 v25, v55, v55, v25
  s_nop 1
  v_add_f32 v22, v22, v24
  v_add_f32 v23, v23, v25
  v_mov_b32 v24, v22
  s_nop 1
  v_permlane32_swap_b32 v22, v24
  v_add_f32 v22, v22, v24
  v_mov_b32 v24, v23
  s_nop 1
  v_permlane32_swap_b32 v23, v24
  v_add_f32 v23, v23, v24
  s_add_u32 s39, s39, 1
  s_mul_i32 s46, s39, 229376
  s_mul_i32 s47, s36, 14
  s_add_u32 s47, s47, s37
  s_lshl_b32 s47, s47, 8
  s_add_u32 s46, s46, s47
  s_add_u32 s46, s46, 5218304
  v_lshlrev_b32 v24, 3, v2
  s_mov_b64 exec, s[64:65]
  buffer_store_dwordx2 v[22:23], v24, s[8:11], s46 offen offset:0 sc1
  s_mov_b64 exec, -1
  s_lshr_b32 s41, s80, 1
  s_lshl_b32 s41, s41, 7
  s_add_u32 s41, s41, s84
  s_and_b32 s42, s80, 1
  s_mul_i32 s42, s42, 7
  s_add_u32 s42, s42, s81
  s_lshl_b32 s42, s42, 2
  s_add_u32 s41, s41, s42
  s_add_u32 s41, s41, 8192
  s_waitcnt vmcnt(0) lgkmcnt(0)
  s_barrier
  s_cmp_lg_u32 s3, 0
  s_cbranch_scc1 L_sig_66
  v_mov_b32 v4, s41
  s_mov_b64 exec, 1
  buffer_store_dword v3, v4, s[12:15], 0 offen sc1
  buffer_store_dword v3, v4, s[92:95], 0 offen
  s_mov_b64 exec, -1
L_sig_66:
  s_mul_i32 s96, s83, 118784
  s_add_u32 s96, s96, 2038784
  s_lshl_b32 s97, s3, 13
  s_add_u32 s96, s96, s97
  s_mov_b32 m0, s97
  s_nop 0
  buffer_load_dwordx4 v1, s[8:11], s96 offen offset:0 sc1 lds
  buffer_load_dwordx4 v1, s[8:11], s96 offen offset:1024 sc1 lds
  buffer_load_dwordx4 v1, s[8:11], s96 offen offset:2048 sc1 lds
  buffer_load_dwordx4 v1, s[8:11], s96 offen offset:3072 sc1 lds
  s_add_u32 s96, s96, 4096
  s_add_u32 s97, s97, 4096
  s_mov_b32 m0, s97
  s_nop 0
  buffer_load_dwordx4 v1, s[8:11], s96 offen offset:0 sc1 lds
  buffer_load_dwordx4 v1, s[8:11], s96 offen offset:1024 sc1 lds
  buffer_load_dwordx4 v1, s[8:11], s96 offen offset:2048 sc1 lds
  buffer_load_dwordx4 v1, s[8:11], s96 offen offset:3072 sc1 lds
  s_lshl_b32 s32, s82, 2
  s_add_u32 s32, s32, s3
  s_lshl_b32 s34, s82, 7
  s_add_u32 s34, s34, s84
  s_add_u32 s34, s34, 8192
  s_cmp_lg_u32 s3, 0
  s_cbranch_scc1 L_wd_67
  s_cmp_lg_u32 s60, 0
  s_cbranch_scc1 L_wd_67
  v_lshlrev_b32 v4, 2, v2
  v_add_u32 v4, s34, v4
  s_mov_b32 exec_lo, 0x00003fff
  s_mov_b32 exec_hi, 0x00000000
  s_mov_b32 s58, 0
L_poll_68:
  buffer_load_dword v7, v4, s[8:11], 0 offen sc1
  s_waitcnt vmcnt(0)
  v_cmp_eq_u32 vcc, 1, v7
  s_add_u32 s58, s58, 1
  s_cmp_eq_u64 vcc, exec
  s_cbranch_scc1 L_wd_67_d
  s_cmp_lt_u32 s58, 60000
  s_cbranch_scc1 L_poll_68
  s_or_b32 s60, s60, 1
L_wd_67_d:
  s_mov_b64 exec, -1
L_wd_67:
  s_waitcnt vmcnt(0) lgkmcnt(0)
  s_barrier
  s_lshl_b32 s36, s6, 1
  s_add_u32 s36, s36, 1
  s_mul_i32 s37, s36, 229376
  s_mul_i32 s35, s32, 3584
  s_add_u32 s37, s37, s35
  s_add_u32 s37, s37, 5218304
  s_mul_i32 s34, s36, 1835008
  s_mul_i32 s35, s32, 28672
  s_add_u32 s34, s34, s35
  s_add_u32 s34, s34, 6135808
  s_mov_b32 s40, s34
  s_add_u32 s41, s40, 4096
  s_add_u32 s42, s40, 8192
  s_add_u32 s43, s40, 12288
  s_add_u32 s44, s40, 16384
  s_add_u32 s45, s40, 20480
  s_add_u32 s46, s40, 24576
  buffer_load_dwordx4 v[144:147], v1, s[8:11], s40 offen offset:0 sc1
  buffer_load_dwordx4 v[148:151], v1, s[8:11], s40 offen offset:1024 sc1
  buffer_load_dwordx4 v[152:155], v1, s[8:11], s40 offen offset:2048 sc1
  buffer_load_dwordx4 v[156:159], v1, s[8:11], s40 offen offset:3072 sc1
  buffer_load_dwordx4 v[160:163], v1, s[8:11], s41 offen offset:0 sc1
  buffer_load_dwordx4 v[164:167], v1, s[8:11], s41 offen offset:1024 sc1
  buffer_load_dwordx4 v[168:171], v1, s[8:11], s41 offen offset:2048 sc1
  buffer_load_dwordx4 v[172:175], v1, s[8:11], s41 offen offset:3072 sc1
  v_and_b32 v4, 31, v2
  v_lshlrev_b32 v4, 3, v4
  v_lshrrev_b32 v7, 5, v2
  v_lshl_add_u32 v4, v7, 8, v4
  s_mul_i32 s38, s32, 112
  s_lshl_b32 s39, s83, 3
  s_add_u32 s38, s38, s39
  s_lshl_b32 s38, s38, 10
  s_add_u32 s38, s38, s68
  s_add_u32 s38, s38, 8388608
  s_add_u32 s39, s38, 4096
  buffer_load_dwordx4 v[176:179], v1, s[8:11], s42 offen offset:0 sc1
  ds_read_b128 v[80:83], v1 offset:53248
  ds_read_b128 v[84:87], v5 offset:17408
  ds_read_b128 v[88:91], v1 offset:54272
  ds_read_b128 v[92:95], v5 offset:18432
  ds_read_b128 v[48:51], v1 offset:55296
  ds_read_b128 v[52:55], v5 offset:19456
  s_waitcnt vmcnt(8) lgkmcnt(5)
  v_mfma_f32_32x32x16_bf16 v[16:31], v[80:83], v[144:147], 0
  s_waitcnt lgkmcnt(4)
  v_mfma_f32_32x32x16_bf16 v[32:47], v[84:87], v[144:147], 0
  buffer_load_dwordx4 v[180:183], v1, s[8:11], s42 offen offset:1024 sc1
  ds_read_b128 v[80:83], v1 offset:56320
  ds_read_b128 v[84:87], v5 offset:20480
  s_waitcnt vmcnt(8) lgkmcnt(5)
  v_mfma_f32_32x32x16_bf16 v[16:31], v[88:91], v[148:151], v[16:31]
  s_waitcnt lgkmcnt(4)
  v_mfma_f32_32x32x16_bf16 v[32:47], v[92:95], v[148:151], v[32:47]
  buffer_load_dwordx4 v[184:187], v1, s[8:11], s42 offen offset:2048 sc1
  buffer_load_dwordx2 v[96:97], v4, s[8:11], s37 offen offset:0 sc1
  ds_read_b128 v[88:91], v1 offset:57344
  ds_read_b128 v[92:95], v5 offset:21504
  s_waitcnt vmcnt(9) lgkmcnt(5)
  v_mfma_f32_32x32x16_bf16 v[16:31], v[48:51], v[152:155], v[16:31]
  s_waitcnt lgkmcnt(4)
  v_mfma_f32_32x32x16_bf16 v[32:47], v[52:55], v[152:155], v[32:47]
  buffer_load_dwordx4 v[188:191], v1, s[8:11], s42 offen offset:3072 sc1
  buffer_load_dwordx2 v[98:99], v4, s[8:11], s37 offen offset:512 sc1
  ds_read_b128 v[48:51], v1 offset:58368
  ds_read_b128 v[52:55], v5 offset:22528
  s_waitcnt vmcnt(10) lgkmcnt(5)
  v_mfma_f32_32x32x16_bf16 v[16:31], v[80:83], v[156:159], v[16:31]
  s_waitcnt lgkmcnt(4)
  v_mfma_f32_32x32x16_bf16 v[32:47], v[84:87], v[156:159], v[32:47]
  buffer_load_dwordx4 v[192:195], v1, s[8:11], s43 offen offset:0 sc1
  buffer_load_dwordx2 v[100:101], v4, s[8:11], s37 offen offset:1024 sc1
  ds_read_b128 v[80:83], v1 offset:59392
  ds_read_b128 v[84:87], v5 offset:23552
  s_waitcnt vmcnt(11) lgkmcnt(5)
  v_mfma_f32_32x32x16_bf16 v[16:31], v[88:91], v[160:163], v[16:31]
  s_waitcnt lgkmcnt(4)
  v_mfma_f32_32x32x16_bf16 v[32:47], v[92:95], v[160:163], v[32:47]
  buffer_load_dwordx4 v[196:199], v1, s[8:11], s43 offen offset:1024 sc1
  buffer_load_dwordx2 v[102:103], v4, s[8:11], s37 offen offset:1536 sc1
  ds_read_b128 v[88:91], v1 offset:60416
  ds_read_b128 v[92:95], v5 offset:24576
  s_waitcnt vmcnt(12) lgkmcnt(5)
  v_mfma_f32_32x32x16_bf16 v[16:31], v[48:51], v[164:167], v[16:31]
  s_waitcnt lgkmcnt(4)
  v_mfma_f32_32x32x16_bf16 v[32:47], v[52:55], v[164:167], v[32:47]
  buffer_load_dwordx4 v[200:203], v1, s[8:11], s43 offen offset:2048 sc1
  buffer_load_dwordx2 v[104:105], v4, s[8:11], s37 offen offset:2048 sc1
  ds_read_b128 v[48:51], v1 offset:61440
  ds_read_b128 v[52:55], v5 offset:25600
  s_waitcnt vmcnt(13) lgkmcnt(5)
  v_mfma_f32_32x32x16_bf16 v[16:31], v[80:83], v[168:171], v[16:31]
  s_waitcnt lgkmcnt(4)
  v_mfma_f32_32x32x16_bf16 v[32:47], v[84:87], v[168:171], v[32:47]
  buffer_load_dwordx4 v[204:207], v1, s[8:11], s43 offen offset:3072 sc1
  buffer_load_dwordx2 v[106:107], v4, s[8:11], s37 offen offset:2560 sc1
  ds_read_b128 v[80:83], v1 offset:62464
  ds_read_b128 v[84:87], v5 offset:26624
  s_waitcnt vmcnt(14) lgkmcnt(5)
  v_mfma_f32_32x32x16_bf16 v[16:31], v[88:91], v[172:175], v[16:31]
  s_waitcnt lgkmcnt(4)
  v_mfma_f32_32x32x16_bf16 v[32:47], v[92:95], v[172:175], v[32:47]
  buffer_load_dwordx4 v[208:211], v1, s[8:11], s44 offen offset:0 sc1
  buffer_load_dwordx2 v[108:109], v4, s[8:11], s37 offen offset:3072 sc1
  ds_read_b128 v[88:91], v1 offset:63488
  ds_read_b128 v[92:95], v5 offset:27648
  s_waitcnt vmcnt(15) lgkmcnt(5)
  v_mfma_f32_32x32x16_bf16 v[16:31], v[48:51], v[176:179], v[16:31]
  s_waitcnt lgkmcnt(4)
  v_mfma_f32_32x32x16_bf16 v[32:47], v[52:55], v[176:179], v[32:47]
  buffer_load_dwordx4 v[212:215], v1, s[8:11], s44 offen offset:1024 sc1
  ds_read_b128 v[48:51], v1 offset:64512
  ds_read_b128 v[52:55], v5 offset:28672
  s_waitcnt vmcnt(15) lgkmcnt(5)
  v_mfma_f32_32x32x16_bf16 v[16:31], v[80:83], v[180:183], v[16:31]
  s_waitcnt lgkmcnt(4)
  v_mfma_f32_32x32x16_bf16 v[32:47], v[84:87], v[180:183], v[32:47]
  buffer_load_dwordx4 v[216:219], v1, s[8:11], s44 offen offset:2048 sc1
  ds_read_b128 v[80:83], v5 offset:0
  ds_read_b128 v[84:87], v5 offset:29696
  s_waitcnt vmcnt(15) lgkmcnt(5)
  v_mfma_f32_32x32x16_bf16 v[16:31], v[88:91], v[184:187], v[16:31]
  s_waitcnt lgkmcnt(4)
  v_mfma_f32_32x32x16_bf16 v[32:47], v[92:95], v[184:187], v[32:47]
  buffer_load_dwordx4 v[220:223], v1, s[8:11], s44 offen offset:3072 sc1
  ds_read_b128 v[88:91], v5 offset:1024
  ds_read_b128 v[92:95], v5 offset:30720
  s_waitcnt vmcnt(14) lgkmcnt(5)
  v_mfma_f32_32x32x16_bf16 v[16:31], v[48:51], v[188:191], v[16:31]
  s_waitcnt lgkmcnt(4)
  v_mfma_f32_32x32x16_bf16 v[32:47], v[52:55], v[188:191], v[32:47]
  buffer_load_dwordx4 v[224:227], v1, s[8:11], s45 offen offset:0 sc1
  ds_read_b128 v[48:51], v5 offset:2048
  ds_read_b128 v[52:55], v5 offset:31744
  s_waitcnt vmcnt(13) lgkmcnt(5)
  v_mfma_f32_32x32x16_bf16 v[16:31], v[80:83], v[192:195], v[16:31]
  s_waitcnt lgkmcnt(4)
  v_mfma_f32_32x32x16_bf16 v[32:47], v[84:87], v[192:195], v[32:47]
  buffer_load_dwordx4 v[228:231], v1, s[8:11], s45 offen offset:1024 sc1
  ds_read_b128 v[80:83], v5 offset:3072
  ds_read_b128 v[84:87], v5 offset:32768
  s_waitcnt vmcnt(12) lgkmcnt(5)
  v_mfma_f32_32x32x16_bf16 v[16:31], v[88:91], v[196:199], v[16:31]
  s_waitcnt lgkmcnt(4)
  v_mfma_f32_32x32x16_bf16 v[32:47], v[92:95], v[196:199], v[32:47]
  buffer_load_dwordx4 v[232:235], v1, s[8:11], s45 offen offset:2048 sc1
  ds_read_b128 v[88:91], v5 offset:4096
  ds_read_b128 v[92:95], v5 offset:33792
  s_waitcnt vmcnt(11) lgkmcnt(5)
  v_mfma_f32_32x32x16_bf16 v[16:31], v[48:51], v[200:203], v[16:31]
  s_waitcnt lgkmcnt(4)
  v_mfma_f32_32x32x16_bf16 v[32:47], v[52:55], v[200:203], v[32:47]
  buffer_load_dwordx4 v[236:239], v1, s[8:11], s45 offen offset:3072 sc1
  ds_read_b128 v[48:51], v5 offset:5120
  ds_read_b128 v[52:55], v5 offset:34816
  s_waitcnt vmcnt(10) lgkmcnt(5)
  v_mfma_f32_32x32x16_bf16 v[16:31], v[80:83], v[204:207], v[16:31]
  s_waitcnt lgkmcnt(4)
  v_mfma_f32_32x32x16_bf16 v[32:47], v[84:87], v[204:207], v[32:47]
  buffer_load_dwordx4 v[240:243], v1, s[8:11], s46 offen offset:0 sc1
  ds_read_b128 v[80:83], v5 offset:6144
  ds_read_b128 v[84:87], v5 offset:35840
  s_waitcnt vmcnt(9) lgkmcnt(5)
  v_mfma_f32_32x32x16_bf16 v[16:31], v[88:91], v[208:211], v[16:31]
  s_waitcnt lgkmcnt(4)
  v_mfma_f32_32x32x16_bf16 v[32:47], v[92:95], v[208:211], v[32:47]
  buffer_load_dwordx4 v[244:247], v1, s[8:11], s46 offen offset:1024 sc1
  ds_read_b128 v[88:91], v5 offset:7168
  ds_read_b128 v[92:95], v5 offset:36864
  s_waitcnt vmcnt(8) lgkmcnt(5)
  v_mfma_f32_32x32x16_bf16 v[16:31], v[48:51], v[212:215], v[16:31]
  s_waitcnt lgkmcnt(4)
  v_mfma_f32_32x32x16_bf16 v[32:47], v[52:55], v[212:215], v[32:47]
  buffer_load_dwordx4 v[248:251], v1, s[8:11], s46 offen offset:2048 sc1
  ds_read_b128 v[48:51], v5 offset:8192
  ds_read_b128 v[52:55], v5 offset:37888
  s_waitcnt vmcnt(8) lgkmcnt(5)
  v_mfma_f32_32x32x16_bf16 v[16:31], v[80:83], v[216:219], v[16:31]
  s_waitcnt lgkmcnt(4)
  v_mfma_f32_32x32x16_bf16 v[32:47], v[84:87], v[216:219], v[32:47]
  buffer_load_dwordx4 v[252:255], v1, s[8:11], s46 offen offset:3072 sc1
  ds_read_b128 v[80:83], v5 offset:9216
  ds_read_b128 v[84:87], v5 offset:38912
  s_waitcnt vmcnt(8) lgkmcnt(5)
  v_mfma_f32_32x32x16_bf16 v[16:31], v[88:91], v[220:223], v[16:31]
  s_waitcnt lgkmcnt(4)
  v_mfma_f32_32x32x16_bf16 v[32:47], v[92:95], v[220:223], v[32:47]
  ds_read_b128 v[88:91], v5 offset:10240
  ds_read_b128 v[92:95], v5 offset:39936
  s_waitcnt vmcnt(7) lgkmcnt(5)
  v_mfma_f32_32x32x16_bf16 v[16:31], v[48:51], v[224:227], v[16:31]
  s_waitcnt lgkmcnt(4)
  v_mfma_f32_32x32x16_bf16 v[32:47], v[52:55], v[224:227], v[32:47]
  ds_read_b128 v[48:51], v5 offset:11264
  ds_read_b128 v[52:55], v5 offset:40960
  s_waitcnt vmcnt(6) lgkmcnt(5)
  v_mfma_f32_32x32x16_bf16 v[16:31], v[80:83], v[228:231], v[16:31]
  s_waitcnt lgkmcnt(4)
  v_mfma_f32_32x32x16_bf16 v[32:47], v[84:87], v[228:231], v[32:47]
  ds_read_b128 v[80:83], v5 offset:12288
  ds_read_b128 v[84:87], v5 offset:41984
  s_waitcnt vmcnt(5) lgkmcnt(5)
  v_mfma_f32_32x32x16_bf16 v[16:31], v[88:91], v[232:235], v[16:31]
  s_waitcnt lgkmcnt(4)
  v_mfma_f32_32x32x16_bf16 v[32:47], v[92:95], v[232:235], v[32:47]
  ds_read_b128 v[88:91], v5 offset:13312
  ds_read_b128 v[92:95], v5 offset:43008
  s_waitcnt vmcnt(4) lgkmcnt(5)
  v_mfma_f32_32x32x16_bf16 v[16:31], v[48:51], v[236:239], v[16:31]
  s_waitcnt lgkmcnt(4)
  v_mfma_f32_32x32x16_bf16 v[32:47], v[52:55], v[236:239], v[32:47]
  ds_read_b128 v[48:51], v5 offset:14336
  ds_read_b128 v[52:55], v5 offset:44032
  s_waitcnt vmcnt(3) lgkmcnt(5)
  v_mfma_f32_32x32x16_bf16 v[16:31], v[80:83], v[240:243], v[16:31]
  s_waitcnt lgkmcnt(4)
  v_mfma_f32_32x32x16_bf16 v[32:47], v[84:87], v[240:243], v[32:47]
  ds_read_b128 v[80:83], v5 offset:15360
  ds_read_b128 v[84:87], v5 offset:45056
  s_waitcnt vmcnt(2) lgkmcnt(5)
  v_mfma_f32_32x32x16_bf16 v[16:31], v[88:91], v[244:247], v[16:31]
  s_waitcnt lgkmcnt(4)
  v_mfma_f32_32x32x16_bf16 v[32:47], v[92:95], v[244:247], v[32:47]
  v_add_f32 v96, v96, v98
  v_add_f32 v97, v97, v99
  v_add_f32 v96, v96, v100
  v_add_f32 v97, v97, v101
  v_add_f32 v96, v96, v102
  v_add_f32 v97, v97, v103
  v_add_f32 v96, v96, v104
  v_add_f32 v97, v97, v105
  v_add_f32 v96, v96, v106
  v_add_f32 v97, v97, v107
  v_add_f32 v96, v96, v108
  v_add_f32 v97, v97, v109
  v_mov_b32 v143, v96
  s_nop 1
  v_permlane32_swap_b32 v96, v143
  v_add_f32 v96, v96, v143
  v_mov_b32 v143, v97
  s_nop 1
  v_permlane32_swap_b32 v97, v143
  v_add_f32 v97, v97, v143
  v_mul_f32 v96, 0x3b124925, v96
  v_mul_f32 v97, 0x3b124925, v97
  v_fma_f32 v97, -v96, v96, v97
  v_max_f32 v97, 0, v97
  v_add_f32 v97, 0x3727c5ac, v97
  v_rsq_f32 v14, v97
  v_sub_f32 v96, 0, v96
  v_cvt_pk_bf16_f32 v10, v96, v96
  v_mul_f32 v97, v97, v14
  v_lshlrev_b32 v143, 16, v10
  v_sub_f32 v143, v96, v143
  v_cvt_pk_bf16_f32 v11, v143, v97
  v_and_b32 v143, 0xffff0000, v11
  v_sub_f32 v143, v97, v143
  v_cvt_pk_bf16_f32 v12, v143, 0
  v_mov_b32 v13, 0
  v_cndmask_b32 v10, 0, v10, s[64:65]
  v_cndmask_b32 v11, 0, v11, s[64:65]
  v_cndmask_b32 v12, 0, v12, s[64:65]
  v_mul_f32 v15, 0x3fb8aa3b, v14
  ds_read_b128 v[88:91], v5 offset:16384
  ds_read_b128 v[92:95], v5 offset:46080
  s_waitcnt vmcnt(1) lgkmcnt(5)
  v_mfma_f32_32x32x16_bf16 v[16:31], v[48:51], v[248:251], v[16:31]
  s_waitcnt lgkmcnt(4)
  v_mfma_f32_32x32x16_bf16 v[32:47], v[52:55], v[248:251], v[32:47]
  ds_read_b128 v[96:99], v5 offset:47104
  ds_read_b128 v[100:103], v1 offset:0
  s_waitcnt vmcnt(0) lgkmcnt(5)
  v_mfma_f32_32x32x16_bf16 v[16:31], v[80:83], v[252:255], v[16:31]
  s_waitcnt lgkmcnt(4)
  v_mfma_f32_32x32x16_bf16 v[32:47], v[84:87], v[252:255], v[32:47]
  ds_read_b128 v[80:83], v5 offset:48128
  ds_read_b128 v[84:87], v1 offset:1024
  s_waitcnt lgkmcnt(5)
  v_mfma_f32_32x32x16_bf16 v[16:31], v[88:91], v[10:13], v[16:31]
  s_waitcnt lgkmcnt(4)
  v_mfma_f32_32x32x16_bf16 v[32:47], v[92:95], v[10:13], v[32:47]
  s_and_b32 s98, s3, 1
  s_xor_b32 s98, s98, 0
  s_lshl_b32 s99, s81, 1
  s_add_u32 s98, s98, s99
  s_mul_i32 s98, s98, 112
  s_mul_i32 s99, s3, 28
  s_add_u32 s98, s98, s99
  s_lshl_b32 s98, s98, 10
  s_add_u32 s96, s98, 3612672
  s_add_u32 s96, s96, 16384
  buffer_load_dwordx4 a[0:3], v1, s[8:11], s96 offen offset:0 sc1
  ds_read_b128 v[88:91], v5 offset:49152
  ds_read_b128 v[92:95], v1 offset:2048
  s_waitcnt lgkmcnt(5)
  v_mfma_f32_32x32x16_bf16 v[48:63], v[96:99], v[144:147], 0
  s_waitcnt lgkmcnt(4)
  v_mfma_f32_32x32x16_bf16 v[64:79], v[100:103], v[144:147], 0
  v_mul_f32 v16, v16, v15
  v_mul_f32 v17, v17, v15
  v_mul_f32 v18, v18, v15
  v_mul_f32 v19, v19, v15
  v_exp_f32 v110, v16
  v_exp_f32 v111, v17
  v_exp_f32 v112, v18
  v_exp_f32 v113, v19
  ds_read_b128 v[96:99], v5 offset:50176
  ds_read_b128 v[100:103], v1 offset:3072
  s_waitcnt lgkmcnt(5)
  v_mfma_f32_32x32x16_bf16 v[48:63], v[80:83], v[148:151], v[48:63]
  s_waitcnt lgkmcnt(4)
  v_mfma_f32_32x32x16_bf16 v[64:79], v[84:87], v[148:151], v[64:79]
  v_fma_f32 v114, v110, 0.5, 1.0
  v_fma_f32 v115, v111, 0.5, 1.0
  v_fma_f32 v116, v112, 0.5, 1.0
  v_fma_f32 v117, v113, 0.5, 1.0
  v_fma_f32 v114, v110, v114, 1.0
  v_fma_f32 v115, v111, v115, 1.0
  v_fma_f32 v116, v112, v116, 1.0
  buffer_load_dwordx4 a[8:11], v1, s[8:11], s96 offen offset:1024 sc1
  ds_read_b128 v[80:83], v5 offset:51200
  ds_read_b128 v[84:87], v1 offset:4096
  s_waitcnt lgkmcnt(5)
  v_mfma_f32_32x32x16_bf16 v[48:63], v[88:91], v[152:155], v[48:63]
  s_waitcnt lgkmcnt(4)
  v_mfma_f32_32x32x16_bf16 v[64:79], v[92:95], v[152:155], v[64:79]
  v_fma_f32 v117, v113, v117, 1.0
  v_rcp_f32 v114, v114
  v_rcp_f32 v115, v115
  v_rcp_f32 v116, v116
  v_rcp_f32 v117, v117
  v_fma_f32 v16, -v16, v114, v16
  v_fma_f32 v17, -v17, v115, v17
  ds_read_b128 v[88:91], v5 offset:52224
  ds_read_b128 v[92:95], v1 offset:5120
  s_waitcnt lgkmcnt(5)
  v_mfma_f32_32x32x16_bf16 v[48:63], v[96:99], v[156:159], v[48:63]
  s_waitcnt lgkmcnt(4)
  v_mfma_f32_32x32x16_bf16 v[64:79], v[100:103], v[156:159], v[64:79]
  v_fma_f32 v18, -v18, v116, v18
  v_fma_f32 v19, -v19, v117, v19
  v_cvt_pk_bf16_f32 v118, v16, v17
  v_cvt_pk_bf16_f32 v119, v18, v19
  v_mul_f32 v20, v20, v15
  v_mul_f32 v21, v21, v15
  v_mul_f32 v22, v22, v15
  v_mul_f32 v23, v23, v15
  buffer_load_dwordx4 a[16:19], v1, s[8:11], s96 offen offset:2048 sc1
  ds_read_b128 v[96:99], v5 offset:53248
  ds_read_b128 v[100:103], v1 offset:6144
  s_waitcnt lgkmcnt(5)
  v_mfma_f32_32x32x16_bf16 v[48:63], v[80:83], v[160:163], v[48:63]
  s_waitcnt lgkmcnt(4)
  v_mfma_f32_32x32x16_bf16 v[64:79], v[84:87], v[160:163], v[64:79]
  v_exp_f32 v110, v20
  v_exp_f32 v111, v21
  v_exp_f32 v112, v22
  v_exp_f32 v113, v23
  v_fma_f32 v114, v110, 0.5, 1.0
  v_fma_f32 v115, v111, 0.5, 1.0
  v_fma_f32 v116, v112, 0.5, 1.0
  ds_read_b128 v[80:83], v5 offset:54272
  ds_read_b128 v[84:87], v1 offset:7168
  s_waitcnt lgkmcnt(5)
  v_mfma_f32_32x32x16_bf16 v[48:63], v[88:91], v[164:167], v[48:63]
  s_waitcnt lgkmcnt(4)
  v_mfma_f32_32x32x16_bf16 v[64:79], v[92:95], v[164:167], v[64:79]
  v_fma_f32 v117, v113, 0.5, 1.0
  v_fma_f32 v114, v110, v114, 1.0
  v_fma_f32 v115, v111, v115, 1.0
  v_fma_f32 v116, v112, v116, 1.0
  v_fma_f32 v117, v113, v117, 1.0
  v_rcp_f32 v114, v114
  v_rcp_f32 v115, v115
  buffer_load_dwordx4 a[24:27], v1, s[8:11], s96 offen offset:3072 sc1
  ds_read_b128 v[88:91], v5 offset:55296
  ds_read_b128 v[92:95], v1 offset:8192
  s_waitcnt lgkmcnt(5)
  v_mfma_f32_32x32x16_bf16 v[48:63], v[96:99], v[168:171], v[48:63]
  s_waitcnt lgkmcnt(4)
  v_mfma_f32_32x32x16_bf16 v[64:79], v[100:103], v[168:171], v[64:79]
  v_rcp_f32 v116, v116
  v_rcp_f32 v117, v117
  v_fma_f32 v20, -v20, v114, v20
  v_fma_f32 v21, -v21, v115, v21
  v_fma_f32 v22, -v22, v116, v22
  v_fma_f32 v23, -v23, v117, v23
  v_cvt_pk_bf16_f32 v120, v20, v21
  v_cvt_pk_bf16_f32 v121, v22, v23
  ds_read_b128 v[96:99], v5 offset:56320
  ds_read_b128 v[100:103], v1 offset:9216
  s_waitcnt lgkmcnt(5)
  v_mfma_f32_32x32x16_bf16 v[48:63], v[80:83], v[172:175], v[48:63]
  s_waitcnt lgkmcnt(4)
  v_mfma_f32_32x32x16_bf16 v[64:79], v[84:87], v[172:175], v[64:79]
  buffer_store_dwordx4 v[118:121], v1, s[8:11], s38 offen offset:0 sc1
  v_mul_f32 v24, v24, v15
  v_mul_f32 v25, v25, v15
  v_mul_f32 v26, v26, v15
  v_mul_f32 v27, v27, v15
  v_exp_f32 v110, v24
  v_exp_f32 v111, v25
  s_add_u32 s96, s96, 4096
  buffer_load_dwordx4 a[32:35], v1, s[8:11], s96 offen offset:0 sc1
  ds_read_b128 v[80:83], v5 offset:57344
  ds_read_b128 v[84:87], v1 offset:10240
  s_waitcnt lgkmcnt(5)
  v_mfma_f32_32x32x16_bf16 v[48:63], v[88:91], v[176:179], v[48:63]
  s_waitcnt lgkmcnt(4)
  v_mfma_f32_32x32x16_bf16 v[64:79], v[92:95], v[176:179], v[64:79]
  v_exp_f32 v112, v26
  v_exp_f32 v113, v27
  v_fma_f32 v114, v110, 0.5, 1.0
  v_fma_f32 v115, v111, 0.5, 1.0
  v_fma_f32 v116, v112, 0.5, 1.0
  v_fma_f32 v117, v113, 0.5, 1.0
  v_fma_f32 v114, v110, v114, 1.0
  ds_read_b128 v[88:91], v5 offset:58368
  ds_read_b128 v[92:95], v1 offset:11264
  s_waitcnt lgkmcnt(5)
  v_mfma_f32_32x32x16_bf16 v[48:63], v[96:99], v[180:183], v[48:63]
  s_waitcnt lgkmcnt(4)
  v_mfma_f32_32x32x16_bf16 v[64:79], v[100:103], v[180:183], v[64:79]
  v_fma_f32 v115, v111, v115, 1.0
  v_fma_f32 v116, v112, v116, 1.0
  v_fma_f32 v117, v113, v117, 1.0
  v_rcp_f32 v114, v114
  v_rcp_f32 v115, v115
  v_rcp_f32 v116, v116
  v_rcp_f32 v117, v117
  v_fma_f32 v24, -v24, v114, v24
  buffer_load_dwordx4 a[40:43], v1, s[8:11], s96 offen offset:1024 sc1
  ds_read_b128 v[96:99], v5 offset:59392
  ds_read_b128 v[100:103], v1 offset:12288
  s_waitcnt lgkmcnt(5)
  v_mfma_f32_32x32x16_bf16 v[48:63], v[80:83], v[184:187], v[48:63]
  s_waitcnt lgkmcnt(4)
  v_mfma_f32_32x32x16_bf16 v[64:79], v[84:87], v[184:187], v[64:79]
  v_fma_f32 v25, -v25, v115, v25
  v_fma_f32 v26, -v26, v116, v26
  v_fma_f32 v27, -v27, v117, v27
  v_cvt_pk_bf16_f32 v122, v24, v25
  v_cvt_pk_bf16_f32 v123, v26, v27
  v_mul_f32 v28, v28, v15
  v_mul_f32 v29, v29, v15
  ds_read_b128 v[80:83], v5 offset:60416
  ds_read_b128 v[84:87], v1 offset:13312
  s_waitcnt lgkmcnt(5)
  v_mfma_f32_32x32x16_bf16 v[48:63], v[88:91], v[188:191], v[48:63]
  s_waitcnt lgkmcnt(4)
  v_mfma_f32_32x32x16_bf16 v[64:79], v[92:95], v[188:191], v[64:79]
  v_mul_f32 v30, v30, v15
  v_mul_f32 v31, v31, v15
  v_exp_f32 v110, v28
  v_exp_f32 v111, v29
  v_exp_f32 v112, v30
  v_exp_f32 v113, v31
  v_fma_f32 v114, v110, 0.5, 1.0
  buffer_load_dwordx4 a[48:51], v1, s[8:11], s96 offen offset:2048 sc1
  ds_read_b128 v[88:91], v5 offset:61440
  ds_read_b128 v[92:95], v1 offset:14336
  s_waitcnt lgkmcnt(5)
  v_mfma_f32_32x32x16_bf16 v[48:63], v[96:99], v[192:195], v[48:63]
  s_waitcnt lgkmcnt(4)
  v_mfma_f32_32x32x16_bf16 v[64:79], v[100:103], v[192:195], v[64:79]
  v_fma_f32 v115, v111, 0.5, 1.0
  v_fma_f32 v116, v112, 0.5, 1.0
  v_fma_f32 v117, v113, 0.5, 1.0
  v_fma_f32 v114, v110, v114, 1.0
  v_fma_f32 v115, v111, v115, 1.0
  v_fma_f32 v116, v112, v116, 1.0
  v_fma_f32 v117, v113, v117, 1.0
  v_rcp_f32 v114, v114
  ds_read_b128 v[96:99], v5 offset:62464
  ds_read_b128 v[100:103], v1 offset:15360
  s_waitcnt lgkmcnt(5)
  v_mfma_f32_32x32x16_bf16 v[48:63], v[80:83], v[196:199], v[48:63]
  s_waitcnt lgkmcnt(4)
  v_mfma_f32_32x32x16_bf16 v[64:79], v[84:87], v[196:199], v[64:79]
  v_rcp_f32 v115, v115
  v_rcp_f32 v116, v116
  v_rcp_f32 v117, v117
  v_fma_f32 v28, -v28, v114, v28
  v_fma_f32 v29, -v29, v115, v29
  v_fma_f32 v30, -v30, v116, v30
  v_fma_f32 v31, -v31, v117, v31
  buffer_load_dwordx4 a[56:59], v1, s[8:11], s96 offen offset:3072 sc1
  ds_read_b128 v[80:83], v5 offset:63488
  ds_read_b128 v[84:87], v1 offset:16384
  s_waitcnt lgkmcnt(5)
  v_mfma_f32_32x32x16_bf16 v[48:63], v[88:91], v[200:203], v[48:63]
  s_waitcnt lgkmcnt(4)
  v_mfma_f32_32x32x16_bf16 v[64:79], v[92:95], v[200:203], v[64:79]
  v_cvt_pk_bf16_f32 v124, v28, v29
  v_cvt_pk_bf16_f32 v125, v30, v31
  buffer_store_dwordx4 v[122:125], v1, s[8:11], s38 offen offset:1024 sc1
  v_mul_f32 v32, v32, v15
  v_mul_f32 v33, v33, v15
  v_mul_f32 v34, v34, v15
  v_mul_f32 v35, v35, v15
  ds_read_b128 v[88:91], v5 offset:64512
  ds_read_b128 v[92:95], v1 offset:17408
  s_waitcnt lgkmcnt(5)
  v_mfma_f32_32x32x16_bf16 v[48:63], v[96:99], v[204:207], v[48:63]
  s_waitcnt lgkmcnt(4)
  v_mfma_f32_32x32x16_bf16 v[64:79], v[100:103], v[204:207], v[64:79]
  v_exp_f32 v126, v32
  v_exp_f32 v127, v33
  v_exp_f32 v128, v34
  v_exp_f32 v129, v35
  v_fma_f32 v130, v126, 0.5, 1.0
  v_fma_f32 v131, v127, 0.5, 1.0
  v_fma_f32 v132, v128, 0.5, 1.0
  s_add_u32 s96, s96, 4096
  buffer_load_dwordx4 a[64:67], v1, s[8:11], s96 offen offset:0 sc1
  ds_read_b128 v[96:99], v6 offset:0
  ds_read_b128 v[100:103], v1 offset:18432
  s_waitcnt lgkmcnt(5)
  v_mfma_f32_32x32x16_bf16 v[48:63], v[80:83], v[208:211], v[48:63]
  s_waitcnt lgkmcnt(4)
  v_mfma_f32_32x32x16_bf16 v[64:79], v[84:87], v[208:211], v[64:79]
  v_fma_f32 v133, v129, 0.5, 1.0
  v_fma_f32 v130, v126, v130, 1.0
  v_fma_f32 v131, v127, v131, 1.0
  v_fma_f32 v132, v128, v132, 1.0
  v_fma_f32 v133, v129, v133, 1.0
  v_rcp_f32 v130, v130
  v_rcp_f32 v131, v131
  v_rcp_f32 v132, v132
  ds_read_b128 v[80:83], v6 offset:1024
  ds_read_b128 v[84:87], v1 offset:19456
  s_waitcnt lgkmcnt(5)
  v_mfma_f32_32x32x16_bf16 v[48:63], v[88:91], v[212:215], v[48:63]
  s_waitcnt lgkmcnt(4)
  v_mfma_f32_32x32x16_bf16 v[64:79], v[92:95], v[212:215], v[64:79]
  v_rcp_f32 v133, v133
  v_fma_f32 v32, -v32, v130, v32
  v_fma_f32 v33, -v33, v131, v33
  v_fma_f32 v34, -v34, v132, v34
  v_fma_f32 v35, -v35, v133, v35
  v_cvt_pk_bf16_f32 v134, v32, v33
  v_cvt_pk_bf16_f32 v135, v34, v35
  buffer_load_dwordx4 a[72:75], v1, s[8:11], s96 offen offset:1024 sc1
  ds_read_b128 v[88:91], v6 offset:2048
  ds_read_b128 v[92:95], v1 offset:20480
  s_waitcnt lgkmcnt(5)
  v_mfma_f32_32x32x16_bf16 v[48:63], v[96:99], v[216:219], v[48:63]
  s_waitcnt lgkmcnt(4)
  v_mfma_f32_32x32x16_bf16 v[64:79], v[100:103], v[216:219], v[64:79]
  v_mul_f32 v36, v36, v15
  v_mul_f32 v37, v37, v15
  v_mul_f32 v38, v38, v15
  v_mul_f32 v39, v39, v15
  v_exp_f32 v126, v36
  v_exp_f32 v127, v37
  v_exp_f32 v128, v38
  ds_read_b128 v[96:99], v6 offset:3072
  ds_read_b128 v[100:103], v1 offset:21504
  s_waitcnt lgkmcnt(5)
  v_mfma_f32_32x32x16_bf16 v[48:63], v[80:83], v[220:223], v[48:63]
  s_waitcnt lgkmcnt(4)
  v_mfma_f32_32x32x16_bf16 v[64:79], v[84:87], v[220:223], v[64:79]
  v_exp_f32 v129, v39
  v_fma_f32 v130, v126, 0.5, 1.0
  v_fma_f32 v131, v127, 0.5, 1.0
  v_fma_f32 v132, v128, 0.5, 1.0
  v_fma_f32 v133, v129, 0.5, 1.0
  v_fma_f32 v130, v126, v130, 1.0
  v_fma_f32 v131, v127, v131, 1.0
  v_fma_f32 v132, v128, v132, 1.0
  buffer_load_dwordx4 a[80:83], v1, s[8:11], s96 offen offset:2048 sc1
  ds_read_b128 v[80:83], v6 offset:4096
  ds_read_b128 v[84:87], v1 offset:22528
  s_waitcnt lgkmcnt(5)
  v_mfma_f32_32x32x16_bf16 v[48:63], v[88:91], v[224:227], v[48:63]
  s_waitcnt lgkmcnt(4)
  v_mfma_f32_32x32x16_bf16 v[64:79], v[92:95], v[224:227], v[64:79]
  v_fma_f32 v133, v129, v133, 1.0
  v_rcp_f32 v130, v130
  v_rcp_f32 v131, v131
  v_rcp_f32 v132, v132
  v_rcp_f32 v133, v133
  v_fma_f32 v36, -v36, v130, v36
  v_fma_f32 v37, -v37, v131, v37
  ds_read_b128 v[88:91], v6 offset:5120
  ds_read_b128 v[92:95], v1 offset:23552
  s_waitcnt lgkmcnt(5)
  v_mfma_f32_32x32x16_bf16 v[48:63], v[96:99], v[228:231], v[48:63]
  s_waitcnt lgkmcnt(4)
  v_mfma_f32_32x32x16_bf16 v[64:79], v[100:103], v[228:231], v[64:79]
  v_fma_f32 v38, -v38, v132, v38
  v_fma_f32 v39, -v39, v133, v39
  v_cvt_pk_bf16_f32 v136, v36, v37
  v_cvt_pk_bf16_f32 v137, v38, v39
  buffer_store_dwordx4 v[134:137], v1, s[8:11], s38 offen offset:2048 sc1
  v_mul_f32 v40, v40, v15
  v_mul_f32 v41, v41, v15
  buffer_load_dwordx4 a[88:91], v1, s[8:11], s96 offen offset:3072 sc1
  ds_read_b128 v[96:99], v6 offset:6144
  ds_read_b128 v[100:103], v1 offset:24576
  s_waitcnt lgkmcnt(5)
  v_mfma_f32_32x32x16_bf16 v[48:63], v[80:83], v[232:235], v[48:63]
  s_waitcnt lgkmcnt(4)
  v_mfma_f32_32x32x16_bf16 v[64:79], v[84:87], v[232:235], v[64:79]
  v_mul_f32 v42, v42, v15
  v_mul_f32 v43, v43, v15
  v_exp_f32 v126, v40
  v_exp_f32 v127, v41
  v_exp_f32 v128, v42
  v_exp_f32 v129, v43
  v_fma_f32 v130, v126, 0.5, 1.0
  v_fma_f32 v131, v127, 0.5, 1.0
  ds_read_b128 v[80:83], v6 offset:7168
  ds_read_b128 v[84:87], v1 offset:25600
  s_waitcnt lgkmcnt(5)
  v_mfma_f32_32x32x16_bf16 v[48:63], v[88:91], v[236:239], v[48:63]
  s_waitcnt lgkmcnt(4)
  v_mfma_f32_32x32x16_bf16 v[64:79], v[92:95], v[236:239], v[64:79]
  v_fma_f32 v132, v128, 0.5, 1.0
  v_fma_f32 v133, v129, 0.5, 1.0
  v_fma_f32 v130, v126, v130, 1.0
  v_fma_f32 v131, v127, v131, 1.0
  v_fma_f32 v132, v128, v132, 1.0
  v_fma_f32 v133, v129, v133, 1.0
  v_rcp_f32 v130, v130
  s_and_b32 s98, s3, 1
  s_xor_b32 s98, s98, 1
  s_lshl_b32 s99, s81, 1
  s_add_u32 s98, s98, s99
  s_mul_i32 s98, s98, 112
  s_mul_i32 s99, s3, 28
  s_add_u32 s98, s98, s99
  s_lshl_b32 s98, s98, 10
  s_add_u32 s96, s98, 3612672
  s_add_u32 s96, s96, 16384
  buffer_load_dwordx4 a[4:7], v1, s[8:11], s96 offen offset:0 sc1
  ds_read_b128 v[88:91], v6 offset:8192
  ds_read_b128 v[92:95], v1 offset:26624
  s_waitcnt lgkmcnt(5)
  v_mfma_f32_32x32x16_bf16 v[48:63], v[96:99], v[240:243], v[48:63]
  s_waitcnt lgkmcnt(4)
  v_mfma_f32_32x32x16_bf16 v[64:79], v[100:103], v[240:243], v[64:79]
  v_rcp_f32 v131, v131
  v_rcp_f32 v132, v132
  v_rcp_f32 v133, v133
  v_fma_f32 v40, -v40, v130, v40
  v_fma_f32 v41, -v41, v131, v41
  v_fma_f32 v42, -v42, v132, v42
  v_fma_f32 v43, -v43, v133, v43
  ds_read_b128 v[96:99], v6 offset:9216
  ds_read_b128 v[100:103], v1 offset:27648
  s_waitcnt lgkmcnt(5)
  v_mfma_f32_32x32x16_bf16 v[48:63], v[80:83], v[244:247], v[48:63]
  s_waitcnt lgkmcnt(4)
  v_mfma_f32_32x32x16_bf16 v[64:79], v[84:87], v[244:247], v[64:79]
  v_cvt_pk_bf16_f32 v138, v40, v41
  v_cvt_pk_bf16_f32 v139, v42, v43
  v_mul_f32 v44, v44, v15
  v_mul_f32 v45, v45, v15
  v_mul_f32 v46, v46, v15
  v_mul_f32 v47, v47, v15
  v_exp_f32 v126, v44
  v_exp_f32 v127, v45
  buffer_load_dwordx4 a[12:15], v1, s[8:11], s96 offen offset:1024 sc1
  ds_read_b128 v[80:83], v6 offset:10240
  ds_read_b128 v[84:87], v1 offset:28672
  s_waitcnt lgkmcnt(5)
  v_mfma_f32_32x32x16_bf16 v[48:63], v[88:91], v[248:251], v[48:63]
  s_waitcnt lgkmcnt(4)
  v_mfma_f32_32x32x16_bf16 v[64:79], v[92:95], v[248:251], v[64:79]
  v_exp_f32 v128, v46
  v_exp_f32 v129, v47
  v_fma_f32 v130, v126, 0.5, 1.0
  v_fma_f32 v131, v127, 0.5, 1.0
  v_fma_f32 v132, v128, 0.5, 1.0
  v_fma_f32 v133, v129, 0.5, 1.0
  v_fma_f32 v130, v126, v130, 1.0
  s_waitcnt lgkmcnt(3)
  v_mfma_f32_32x32x16_bf16 v[48:63], v[96:99], v[252:255], v[48:63]
  s_waitcnt lgkmcnt(2)
  v_mfma_f32_32x32x16_bf16 v[64:79], v[100:103], v[252:255], v[64:79]
  v_fma_f32 v131, v127, v131, 1.0
  v_fma_f32 v132, v128, v132, 1.0
  v_fma_f32 v133, v129, v133, 1.0
  v_rcp_f32 v130, v130
  v_rcp_f32 v131, v131
  v_rcp_f32 v132, v132
  v_rcp_f32 v133, v133
  s_waitcnt lgkmcnt(1)
  v_mfma_f32_32x32x16_bf16 v[48:63], v[80:83], v[10:13], v[48:63]
  s_waitcnt lgkmcnt(0)
  v_mfma_f32_32x32x16_bf16 v[64:79], v[84:87], v[10:13], v[64:79]
  v_fma_f32 v44, -v44, v130, v44
  v_fma_f32 v45, -v45, v131, v45
  v_fma_f32 v46, -v46, v132, v46
  v_fma_f32 v47, -v47, v133, v47
  v_cvt_pk_bf16_f32 v140, v44, v45
  v_cvt_pk_bf16_f32 v141, v46, v47
  buffer_store_dwordx4 v[138:141], v1, s[8:11], s38 offen offset:3072 sc1
  buffer_load_dwordx4 a[20:23], v1, s[8:11], s96 offen offset:2048 sc1
  s_nop 1
  v_mul_f32 v48, v48, v15
  v_mul_f32 v49, v49, v15
  v_mul_f32 v50, v50, v15
  v_mul_f32 v51, v51, v15
  v_exp_f32 v110, v48
  v_exp_f32 v111, v49
  v_exp_f32 v112, v50
  v_exp_f32 v113, v51
  v_fma_f32 v114, v110, 0.5, 1.0
  v_fma_f32 v115, v111, 0.5, 1.0
  v_fma_f32 v116, v112, 0.5, 1.0
  v_fma_f32 v117, v113, 0.5, 1.0
  v_fma_f32 v114, v110, v114, 1.0
  v_fma_f32 v115, v111, v115, 1.0
  v_fma_f32 v116, v112, v116, 1.0
  v_fma_f32 v117, v113, v117, 1.0
  v_rcp_f32 v114, v114
  v_rcp_f32 v115, v115
  v_rcp_f32 v116, v116
  v_rcp_f32 v117, v117
  v_fma_f32 v48, -v48, v114, v48
  buffer_load_dwordx4 a[28:31], v1, s[8:11], s96 offen offset:3072 sc1
  v_fma_f32 v49, -v49, v115, v49
  v_fma_f32 v50, -v50, v116, v50
  v_fma_f32 v51, -v51, v117, v51
  v_cvt_pk_bf16_f32 v118, v48, v49
  v_cvt_pk_bf16_f32 v119, v50, v51
  v_mul_f32 v52, v52, v15
  v_mul_f32 v53, v53, v15
  v_mul_f32 v54, v54, v15
  v_mul_f32 v55, v55, v15
  v_exp_f32 v110, v52
  v_exp_f32 v111, v53
  v_exp_f32 v112, v54
  v_exp_f32 v113, v55
  v_fma_f32 v114, v110, 0.5, 1.0
  v_fma_f32 v115, v111, 0.5, 1.0
  v_fma_f32 v116, v112, 0.5, 1.0
  v_fma_f32 v117, v113, 0.5, 1.0
  v_fma_f32 v114, v110, v114, 1.0
  v_fma_f32 v115, v111, v115, 1.0
  v_fma_f32 v116, v112, v116, 1.0
  v_fma_f32 v117, v113, v117, 1.0
  s_add_u32 s96, s96, 4096
  buffer_load_dwordx4 a[36:39], v1, s[8:11], s96 offen offset:0 sc1
  v_rcp_f32 v114, v114
  v_rcp_f32 v115, v115
  v_rcp_f32 v116, v116
  v_rcp_f32 v117, v117
  v_fma_f32 v52, -v52, v114, v52
  v_fma_f32 v53, -v53, v115, v53
  v_fma_f32 v54, -v54, v116, v54
  v_fma_f32 v55, -v55, v117, v55
  v_cvt_pk_bf16_f32 v120, v52, v53
  v_cvt_pk_bf16_f32 v121, v54, v55
  buffer_store_dwordx4 v[118:121], v1, s[8:11], s39 offen offset:0 sc1
  v_mul_f32 v56, v56, v15
  v_mul_f32 v57, v57, v15
  v_mul_f32 v58, v58, v15
  v_mul_f32 v59, v59, v15
  v_exp_f32 v110, v56
  v_exp_f32 v111, v57
  v_exp_f32 v112, v58
  v_exp_f32 v113, v59
  v_fma_f32 v114, v110, 0.5, 1.0
  v_fma_f32 v115, v111, 0.5, 1.0
  buffer_load_dwordx4 a[44:47], v1, s[8:11], s96 offen offset:1024 sc1
  v_fma_f32 v116, v112, 0.5, 1.0
  v_fma_f32 v117, v113, 0.5, 1.0
  v_fma_f32 v114, v110, v114, 1.0
  v_fma_f32 v115, v111, v115, 1.0
  v_fma_f32 v116, v112, v116, 1.0
  v_fma_f32 v117, v113, v117, 1.0
  v_rcp_f32 v114, v114
  v_rcp_f32 v115, v115
  v_rcp_f32 v116, v116
  v_rcp_f32 v117, v117
  v_fma_f32 v56, -v56, v114, v56
  v_fma_f32 v57, -v57, v115, v57
  v_fma_f32 v58, -v58, v116, v58
  v_fma_f32 v59, -v59, v117, v59
  v_cvt_pk_bf16_f32 v122, v56, v57
  v_cvt_pk_bf16_f32 v123, v58, v59
  v_mul_f32 v60, v60, v15
  v_mul_f32 v61, v61, v15
  v_mul_f32 v62, v62, v15
  v_mul_f32 v63, v63, v15
  v_exp_f32 v110, v60
  buffer_load_dwordx4 a[52:55], v1, s[8:11], s96 offen offset:2048 sc1
  v_exp_f32 v111, v61
  v_exp_f32 v112, v62
  v_exp_f32 v113, v63
  v_fma_f32 v114, v110, 0.5, 1.0
  v_fma_f32 v115, v111, 0.5, 1.0
  v_fma_f32 v116, v112, 0.5, 1.0
  v_fma_f32 v117, v113, 0.5, 1.0
  v_fma_f32 v114, v110, v114, 1.0
  v_fma_f32 v115, v111, v115, 1.0
  v_fma_f32 v116, v112, v116, 1.0
  v_fma_f32 v117, v113, v117, 1.0
  v_rcp_f32 v114, v114
  v_rcp_f32 v115, v115
  v_rcp_f32 v116, v116
  v_rcp_f32 v117, v117
  v_fma_f32 v60, -v60, v114, v60
  v_fma_f32 v61, -v61, v115, v61
  v_fma_f32 v62, -v62, v116, v62
  v_fma_f32 v63, -v63, v117, v63
  v_cvt_pk_bf16_f32 v124, v60, v61
  v_cvt_pk_bf16_f32 v125, v62, v63
  buffer_store_dwordx4 v[122:125], v1, s[8:11], s39 offen offset:1024 sc1
  buffer_load_dwordx4 a[60:63], v1, s[8:11], s96 offen offset:3072 sc1
  v_mul_f32 v64, v64, v15
  v_mul_f32 v65, v65, v15
  v_mul_f32 v66, v66, v15
  v_mul_f32 v67, v67, v15
  v_exp_f32 v126, v64
  v_exp_f32 v127, v65
  v_exp_f32 v128, v66
  v_exp_f32 v129, v67
  v_fma_f32 v130, v126, 0.5, 1.0
  v_fma_f32 v131, v127, 0.5, 1.0
  v_fma_f32 v132, v128, 0.5, 1.0
  v_fma_f32 v133, v129, 0.5, 1.0
  v_fma_f32 v130, v126, v130, 1.0
  v_fma_f32 v131, v127, v131, 1.0
  v_fma_f32 v132, v128, v132, 1.0
  v_fma_f32 v133, v129, v133, 1.0
  v_rcp_f32 v130, v130
  v_rcp_f32 v131, v131
  v_rcp_f32 v132, v132
  v_rcp_f32 v133, v133
  v_fma_f32 v64, -v64, v130, v64
  s_add_u32 s96, s96, 4096
  buffer_load_dwordx4 a[68:71], v1, s[8:11], s96 offen offset:0 sc1
  v_fma_f32 v65, -v65, v131, v65
  v_fma_f32 v66, -v66, v132, v66
  v_fma_f32 v67, -v67, v133, v67
  v_cvt_pk_bf16_f32 v134, v64, v65
  v_cvt_pk_bf16_f32 v135, v66, v67
  v_mul_f32 v68, v68, v15
  v_mul_f32 v69, v69, v15
  v_mul_f32 v70, v70, v15
  v_mul_f32 v71, v71, v15
  v_exp_f32 v126, v68
  v_exp_f32 v127, v69
  v_exp_f32 v128, v70
  v_exp_f32 v129, v71
  v_fma_f32 v130, v126, 0.5, 1.0
  v_fma_f32 v131, v127, 0.5, 1.0
  v_fma_f32 v132, v128, 0.5, 1.0
  v_fma_f32 v133, v129, 0.5, 1.0
  v_fma_f32 v130, v126, v130, 1.0
  v_fma_f32 v131, v127, v131, 1.0
  v_fma_f32 v132, v128, v132, 1.0
  v_fma_f32 v133, v129, v133, 1.0
  buffer_load_dwordx4 a[76:79], v1, s[8:11], s96 offen offset:1024 sc1
  v_rcp_f32 v130, v130
  v_rcp_f32 v131, v131
  v_rcp_f32 v132, v132
  v_rcp_f32 v133, v133
  v_fma_f32 v68, -v68, v130, v68
  v_fma_f32 v69, -v69, v131, v69
  v_fma_f32 v70, -v70, v132, v70
  v_fma_f32 v71, -v71, v133, v71
  v_cvt_pk_bf16_f32 v136, v68, v69
  v_cvt_pk_bf16_f32 v137, v70, v71
  buffer_store_dwordx4 v[134:137], v1, s[8:11], s39 offen offset:2048 sc1
  v_mul_f32 v72, v72, v15
  v_mul_f32 v73, v73, v15
  v_mul_f32 v74, v74, v15
  v_mul_f32 v75, v75, v15
  v_exp_f32 v126, v72
  v_exp_f32 v127, v73
  v_exp_f32 v128, v74
  v_exp_f32 v129, v75
  v_fma_f32 v130, v126, 0.5, 1.0
  v_fma_f32 v131, v127, 0.5, 1.0
  buffer_load_dwordx4 a[84:87], v1, s[8:11], s96 offen offset:2048 sc1
  v_fma_f32 v132, v128, 0.5, 1.0
  v_fma_f32 v133, v129, 0.5, 1.0
  v_fma_f32 v130, v126, v130, 1.0
  v_fma_f32 v131, v127, v131, 1.0
  v_fma_f32 v132, v128, v132, 1.0
  v_fma_f32 v133, v129, v133, 1.0
  v_rcp_f32 v130, v130
  v_rcp_f32 v131, v131
  v_rcp_f32 v132, v132
  v_rcp_f32 v133, v133
  v_fma_f32 v72, -v72, v130, v72
  v_fma_f32 v73, -v73, v131, v73
  v_fma_f32 v74, -v74, v132, v74
  v_fma_f32 v75, -v75, v133, v75
  v_cvt_pk_bf16_f32 v138, v72, v73
  v_cvt_pk_bf16_f32 v139, v74, v75
  v_mul_f32 v76, v76, v15
  v_mul_f32 v77, v77, v15
  v_mul_f32 v78, v78, v15
  v_mul_f32 v79, v79, v15
  v_exp_f32 v126, v76
  buffer_load_dwordx4 a[92:95], v1, s[8:11], s96 offen offset:3072 sc1
  v_exp_f32 v127, v77
  v_exp_f32 v128, v78
  v_exp_f32 v129, v79
  v_fma_f32 v130, v126, 0.5, 1.0
  v_fma_f32 v131, v127, 0.5, 1.0
  v_fma_f32 v132, v128, 0.5, 1.0
  v_fma_f32 v133, v129, 0.5, 1.0
  v_fma_f32 v130, v126, v130, 1.0
  v_fma_f32 v131, v127, v131, 1.0
  v_fma_f32 v132, v128, v132, 1.0
  v_fma_f32 v133, v129, v133, 1.0
  v_rcp_f32 v130, v130
  v_rcp_f32 v131, v131
  v_rcp_f32 v132, v132
  v_rcp_f32 v133, v133
  v_fma_f32 v76, -v76, v130, v76
  v_fma_f32 v77, -v77, v131, v77
  v_fma_f32 v78, -v78, v132, v78
  v_fma_f32 v79, -v79, v133, v79
  v_cvt_pk_bf16_f32 v140, v76, v77
  v_cvt_pk_bf16_f32 v141, v78, v79
  buffer_store_dwordx4 v[138:141], v1, s[8:11], s39 offen offset:3072 sc1
  s_lshl_b32 s34, s82, 7
  s_add_u32 s34, s34, s84
  s_lshl_b32 s35, s83, 2
  s_add_u32 s34, s34, s35
  s_add_u32 s34, s34, 12288
  s_waitcnt vmcnt(0) lgkmcnt(0)
  s_barrier
  s_cmp_lg_u32 s3, 0
  s_cbranch_scc1 L_sig_69
  v_mov_b32 v4, s34
  s_mov_b64 exec, 1
  buffer_store_dword v3, v4, s[12:15], 0 offen sc1
  buffer_store_dword v3, v4, s[92:95], 0 offen
  s_mov_b64 exec, -1
L_sig_69:
  s_and_b32 s32, s3, 1
  s_lshr_b32 s33, s3, 1
  s_lshl_b32 s36, s80, 1
  s_add_u32 s36, s36, s33
  s_lshl_b32 s37, s81, 1
  s_add_u32 s37, s37, s32
  s_mul_i32 s38, s36, 28
  s_lshl_b32 s39, s37, 1
  s_add_u32 s38, s38, s39
  s_lshl_b32 s38, s38, 10
  s_lshl_b32 s39, s6, 1
  s_add_u32 s39, s39, 1
  s_mul_i32 s40, s39, 1835008
  s_add_u32 s40, s40, s38
  s_add_u32 s40, s40, 6135808
  buffer_load_dwordx4 v[10:13], v1, s[8:11], s40 offen offset:0 sc1
  buffer_load_dwordx4 v[14:17], v1, s[8:11], s40 offen offset:1024 sc1
  s_lshr_b32 s41, s80, 1
  s_lshl_b32 s41, s41, 7
  s_add_u32 s41, s41, s84
  s_add_u32 s41, s41, 12288
  s_cmp_lg_u32 s3, 0
  s_cbranch_scc1 L_wd_70
  s_cmp_lg_u32 s60, 0
  s_cbranch_scc1 L_wd_70
  v_lshlrev_b32 v4, 2, v2
  v_add_u32 v4, s41, v4
  s_mov_b32 exec_lo, 0x00003fff
  s_mov_b32 exec_hi, 0x00000000
  s_mov_b32 s58, 0
L_poll_71:
  buffer_load_dword v7, v4, s[8:11], 0 offen sc1
  s_waitcnt vmcnt(0)
  v_cmp_eq_u32 vcc, 1, v7
  s_add_u32 s58, s58, 1
  s_cmp_eq_u64 vcc, exec
  s_cbranch_scc1 L_wd_70_d
  s_cmp_lt_u32 s58, 60000
  s_cbranch_scc1 L_poll_71
  s_or_b32 s60, s60, 1
L_wd_70_d:
  s_mov_b64 exec, -1
L_wd_70:
  s_barrier
  s_xor_b32 s34, s33, 0
  s_lshl_b32 s35, s80, 1
  s_add_u32 s34, s34, s35
  s_mul_i32 s34, s34, 112
  s_mul_i32 s35, s3, 28
  s_add_u32 s34, s34, s35
  s_lshl_b32 s34, s34, 10
  s_add_u32 s34, s34, s68
  s_add_u32 s44, s34, 8388608
  s_xor_b32 s34, s33, 1
  s_lshl_b32 s35, s80, 1
  s_add_u32 s34, s34, s35
  s_mul_i32 s34, s34, 112
  s_mul_i32 s35, s3, 28
  s_add_u32 s34, s34, s35
  s_lshl_b32 s34, s34, 10
  s_add_u32 s34, s34, s68
  s_add_u32 s45, s34, 8388608
  s_add_u32 s46, s44, 0
  buffer_load_dwordx4 v[32:35], v1, s[8:11], s46 offen offset:0 sc1
  s_add_u32 s47, s45, 0
  buffer_load_dwordx4 v[36:39], v1, s[8:11], s47 offen offset:0 sc1
  buffer_load_dwordx4 v[40:43], v1, s[8:11], s46 offen offset:1024 sc1
  buffer_load_dwordx4 v[44:47], v1, s[8:11], s47 offen offset:1024 sc1
  buffer_load_dwordx4 v[48:51], v1, s[8:11], s46 offen offset:2048 sc1
  buffer_load_dwordx4 v[52:55], v1, s[8:11], s47 offen offset:2048 sc1
  buffer_load_dwordx4 v[56:59], v1, s[8:11], s46 offen offset:3072 sc1
  buffer_load_dwordx4 v[60:63], v1, s[8:11], s47 offen offset:3072 sc1
  s_add_u32 s46, s44, 4096
  buffer_load_dwordx4 v[64:67], v1, s[8:11], s46 offen offset:0 sc1
  s_add_u32 s47, s45, 4096
  buffer_load_dwordx4 v[68:71], v1, s[8:11], s47 offen offset:0 sc1
  buffer_load_dwordx4 v[72:75], v1, s[8:11], s46 offen offset:1024 sc1
  buffer_load_dwordx4 v[76:79], v1, s[8:11], s47 offen offset:1024 sc1
  s_mov_b32 s48, s8
  s_mov_b32 s49, s9
  s_mov_b32 s51, 0x00020000
  s_cmp_eq_u32 s6, 0
  s_cselect_b32 s50, 0x10000000, 0
  buffer_load_dwordx4 v[80:83], v1, s[8:11], s46 offen offset:2048 sc1
  buffer_load_dwordx4 v[84:87], v1, s[8:11], s47 offen offset:2048 sc1
  s_waitcnt vmcnt(13)
  v_mfma_f32_32x32x16_bf16 v[192:207], a[128:131], v[32:35], 0
  v_mfma_f32_32x32x16_bf16 v[208:223], a[132:135], v[32:35], 0
  s_waitcnt vmcnt(12)
  v_mfma_f32_32x32x16_bf16 v[224:239], a[128:131], v[36:39], 0
  v_mfma_f32_32x32x16_bf16 v[240:255], a[132:135], v[36:39], 0
  buffer_load_dwordx4 v[88:91], v1, s[8:11], s46 offen offset:3072 sc1
  buffer_load_dwordx4 v[92:95], v1, s[8:11], s47 offen offset:3072 sc1
  s_waitcnt vmcnt(13)
  v_mfma_f32_32x32x16_bf16 v[192:207], a[136:139], v[40:43], v[192:207]
  v_mfma_f32_32x32x16_bf16 v[208:223], a[140:143], v[40:43], v[208:223]
  s_waitcnt vmcnt(12)
  v_mfma_f32_32x32x16_bf16 v[224:239], a[136:139], v[44:47], v[224:239]
  v_mfma_f32_32x32x16_bf16 v[240:255], a[140:143], v[44:47], v[240:255]
  s_add_u32 s46, s44, 8192
  buffer_load_dwordx4 v[96:99], v1, s[8:11], s46 offen offset:0 sc1
  s_add_u32 s47, s45, 8192
  buffer_load_dwordx4 v[100:103], v1, s[8:11], s47 offen offset:0 sc1
  s_waitcnt vmcnt(13)
  v_mfma_f32_32x32x16_bf16 v[192:207], a[144:147], v[48:51], v[192:207]
  v_mfma_f32_32x32x16_bf16 v[208:223], a[148:151], v[48:51], v[208:223]
  s_waitcnt vmcnt(12)
  v_mfma_f32_32x32x16_bf16 v[224:239], a[144:147], v[52:55], v[224:239]
  v_mfma_f32_32x32x16_bf16 v[240:255], a[148:151], v[52:55], v[240:255]
  buffer_load_dwordx4 v[104:107], v1, s[8:11], s46 offen offset:1024 sc1
  buffer_load_dwordx4 v[108:111], v1, s[8:11], s47 offen offset:1024 sc1
  s_waitcnt vmcnt(13)
  v_mfma_f32_32x32x16_bf16 v[192:207], a[152:155], v[56:59], v[192:207]
  v_mfma_f32_32x32x16_bf16 v[208:223], a[156:159], v[56:59], v[208:223]
  s_waitcnt vmcnt(12)
  v_mfma_f32_32x32x16_bf16 v[224:239], a[152:155], v[60:63], v[224:239]
  v_mfma_f32_32x32x16_bf16 v[240:255], a[156:159], v[60:63], v[240:255]
  buffer_load_dwordx4 v[112:115], v1, s[8:11], s46 offen offset:2048 sc1
  buffer_load_dwordx4 v[116:119], v1, s[8:11], s47 offen offset:2048 sc1
  s_waitcnt vmcnt(13)
  v_mfma_f32_32x32x16_bf16 v[192:207], a[160:163], v[64:67], v[192:207]
  v_mfma_f32_32x32x16_bf16 v[208:223], a[164:167], v[64:67], v[208:223]
  s_waitcnt vmcnt(12)
  v_mfma_f32_32x32x16_bf16 v[224:239], a[160:163], v[68:71], v[224:239]
  v_mfma_f32_32x32x16_bf16 v[240:255], a[164:167], v[68:71], v[240:255]
  buffer_load_dwordx4 v[120:123], v1, s[8:11], s46 offen offset:3072 sc1
  buffer_load_dwordx4 v[124:127], v1, s[8:11], s47 offen offset:3072 sc1
  s_waitcnt vmcnt(13)
  v_mfma_f32_32x32x16_bf16 v[192:207], a[168:171], v[72:75], v[192:207]
  v_mfma_f32_32x32x16_bf16 v[208:223], a[172:175], v[72:75], v[208:223]
  s_waitcnt vmcnt(12)
  v_mfma_f32_32x32x16_bf16 v[224:239], a[168:171], v[76:79], v[224:239]
  v_mfma_f32_32x32x16_bf16 v[240:255], a[172:175], v[76:79], v[240:255]
  s_add_u32 s46, s44, 12288
  buffer_load_dwordx4 v[128:131], v1, s[8:11], s46 offen offset:0 sc1
  s_add_u32 s47, s45, 12288
  buffer_load_dwordx4 v[132:135], v1, s[8:11], s47 offen offset:0 sc1
  s_waitcnt vmcnt(13)
  v_mfma_f32_32x32x16_bf16 v[192:207], a[176:179], v[80:83], v[192:207]
  v_mfma_f32_32x32x16_bf16 v[208:223], a[180:183], v[80:83], v[208:223]
  s_waitcnt vmcnt(12)
  v_mfma_f32_32x32x16_bf16 v[224:239], a[176:179], v[84:87], v[224:239]
  v_mfma_f32_32x32x16_bf16 v[240:255], a[180:183], v[84:87], v[240:255]
  buffer_load_dwordx4 v[136:139], v1, s[8:11], s46 offen offset:1024 sc1
  buffer_load_dwordx4 v[140:143], v1, s[8:11], s47 offen offset:1024 sc1
  s_waitcnt vmcnt(13)
  v_mfma_f32_32x32x16_bf16 v[192:207], a[184:187], v[88:91], v[192:207]
  v_mfma_f32_32x32x16_bf16 v[208:223], a[188:191], v[88:91], v[208:223]
  s_waitcnt vmcnt(12)
  v_mfma_f32_32x32x16_bf16 v[224:239], a[184:187], v[92:95], v[224:239]
  v_mfma_f32_32x32x16_bf16 v[240:255], a[188:191], v[92:95], v[240:255]
  buffer_load_dwordx4 v[144:147], v1, s[8:11], s46 offen offset:2048 sc1
  buffer_load_dwordx4 v[148:151], v1, s[8:11], s47 offen offset:2048 sc1
  s_waitcnt vmcnt(13)
  v_mfma_f32_32x32x16_bf16 v[192:207], a[192:195], v[96:99], v[192:207]
  v_mfma_f32_32x32x16_bf16 v[208:223], a[196:199], v[96:99], v[208:223]
  s_waitcnt vmcnt(12)
  v_mfma_f32_32x32x16_bf16 v[224:239], a[192:195], v[100:103], v[224:239]
  v_mfma_f32_32x32x16_bf16 v[240:255], a[196:199], v[100:103], v[240:255]
  buffer_load_dwordx4 v[152:155], v1, s[8:11], s46 offen offset:3072 sc1
  buffer_load_dwordx4 v[156:159], v1, s[8:11], s47 offen offset:3072 sc1
  s_waitcnt vmcnt(13)
  v_mfma_f32_32x32x16_bf16 v[192:207], a[200:203], v[104:107], v[192:207]
  v_mfma_f32_32x32x16_bf16 v[208:223], a[204:207], v[104:107], v[208:223]
  s_waitcnt vmcnt(12)
  v_mfma_f32_32x32x16_bf16 v[224:239], a[200:203], v[108:111], v[224:239]
  v_mfma_f32_32x32x16_bf16 v[240:255], a[204:207], v[108:111], v[240:255]
  s_add_u32 s46, s44, 16384
  buffer_load_dwordx4 v[160:163], v1, s[8:11], s46 offen offset:0 sc1
  s_add_u32 s47, s45, 16384
  buffer_load_dwordx4 v[164:167], v1, s[8:11], s47 offen offset:0 sc1
  s_waitcnt vmcnt(13)
  v_mfma_f32_32x32x16_bf16 v[192:207], a[208:211], v[112:115], v[192:207]
  v_mfma_f32_32x32x16_bf16 v[208:223], a[212:215], v[112:115], v[208:223]
  s_waitcnt vmcnt(12)
  v_mfma_f32_32x32x16_bf16 v[224:239], a[208:211], v[116:119], v[224:239]
  v_mfma_f32_32x32x16_bf16 v[240:255], a[212:215], v[116:119], v[240:255]
  buffer_load_dwordx4 v[168:171], v1, s[8:11], s46 offen offset:1024 sc1
  buffer_load_dwordx4 v[172:175], v1, s[8:11], s47 offen offset:1024 sc1
  s_waitcnt vmcnt(13)
  v_mfma_f32_32x32x16_bf16 v[192:207], a[216:219], v[120:123], v[192:207]
  v_mfma_f32_32x32x16_bf16 v[208:223], a[220:223], v[120:123], v[208:223]
  s_waitcnt vmcnt(12)
  v_mfma_f32_32x32x16_bf16 v[224:239], a[216:219], v[124:127], v[224:239]
  v_mfma_f32_32x32x16_bf16 v[240:255], a[220:223], v[124:127], v[240:255]
  buffer_load_dwordx4 v[176:179], v1, s[8:11], s46 offen offset:2048 sc1
  buffer_load_dwordx4 v[180:183], v1, s[8:11], s47 offen offset:2048 sc1
  s_waitcnt vmcnt(13)
  v_mfma_f32_32x32x16_bf16 v[192:207], a[224:227], v[128:131], v[192:207]
  v_mfma_f32_32x32x16_bf16 v[208:223], a[228:231], v[128:131], v[208:223]
  s_waitcnt vmcnt(12)
  v_mfma_f32_32x32x16_bf16 v[224:239], a[224:227], v[132:135], v[224:239]
  v_mfma_f32_32x32x16_bf16 v[240:255], a[228:231], v[132:135], v[240:255]
  buffer_load_dwordx4 v[184:187], v1, s[8:11], s46 offen offset:3072 sc1
  buffer_load_dwordx4 v[188:191], v1, s[8:11], s47 offen offset:3072 sc1
  s_waitcnt vmcnt(13)
  v_mfma_f32_32x32x16_bf16 v[192:207], a[232:235], v[136:139], v[192:207]
  v_mfma_f32_32x32x16_bf16 v[208:223], a[236:239], v[136:139], v[208:223]
  s_waitcnt vmcnt(12)
  v_mfma_f32_32x32x16_bf16 v[224:239], a[232:235], v[140:143], v[224:239]
  v_mfma_f32_32x32x16_bf16 v[240:255], a[236:239], v[140:143], v[240:255]
  s_add_u32 s46, s44, 20480
  buffer_load_dwordx4 v[32:35], v1, s[8:11], s46 offen offset:0 sc1
  s_add_u32 s47, s45, 20480
  buffer_load_dwordx4 v[36:39], v1, s[8:11], s47 offen offset:0 sc1
  s_waitcnt vmcnt(13)
  v_mfma_f32_32x32x16_bf16 v[192:207], a[240:243], v[144:147], v[192:207]
  v_mfma_f32_32x32x16_bf16 v[208:223], a[244:247], v[144:147], v[208:223]
  s_waitcnt vmcnt(12)
  v_mfma_f32_32x32x16_bf16 v[224:239], a[240:243], v[148:151], v[224:239]
  v_mfma_f32_32x32x16_bf16 v[240:255], a[244:247], v[148:151], v[240:255]
  buffer_load_dwordx4 v[40:43], v1, s[8:11], s46 offen offset:1024 sc1
  buffer_load_dwordx4 v[44:47], v1, s[8:11], s47 offen offset:1024 sc1
  s_waitcnt vmcnt(13)
  v_mfma_f32_32x32x16_bf16 v[192:207], a[248:251], v[152:155], v[192:207]
  v_mfma_f32_32x32x16_bf16 v[208:223], a[252:255], v[152:155], v[208:223]
  s_waitcnt vmcnt(12)
  v_mfma_f32_32x32x16_bf16 v[224:239], a[248:251], v[156:159], v[224:239]
  v_mfma_f32_32x32x16_bf16 v[240:255], a[252:255], v[156:159], v[240:255]
  buffer_load_dwordx4 v[48:51], v1, s[8:11], s46 offen offset:2048 sc1
  buffer_load_dwordx4 v[52:55], v1, s[8:11], s47 offen offset:2048 sc1
  s_waitcnt vmcnt(13)
  v_mfma_f32_32x32x16_bf16 v[192:207], a[0:3], v[160:163], v[192:207]
  v_mfma_f32_32x32x16_bf16 v[208:223], a[4:7], v[160:163], v[208:223]
  s_waitcnt vmcnt(12)
  v_mfma_f32_32x32x16_bf16 v[224:239], a[0:3], v[164:167], v[224:239]
  v_mfma_f32_32x32x16_bf16 v[240:255], a[4:7], v[164:167], v[240:255]
  buffer_load_dwordx4 v[56:59], v1, s[8:11], s46 offen offset:3072 sc1
  buffer_load_dwordx4 v[60:63], v1, s[8:11], s47 offen offset:3072 sc1
  s_waitcnt vmcnt(13)
  v_mfma_f32_32x32x16_bf16 v[192:207], a[8:11], v[168:171], v[192:207]
  v_mfma_f32_32x32x16_bf16 v[208:223], a[12:15], v[168:171], v[208:223]
  s_waitcnt vmcnt(12)
  v_mfma_f32_32x32x16_bf16 v[224:239], a[8:11], v[172:175], v[224:239]
  v_mfma_f32_32x32x16_bf16 v[240:255], a[12:15], v[172:175], v[240:255]
  s_add_u32 s46, s44, 24576
  buffer_load_dwordx4 v[64:67], v1, s[8:11], s46 offen offset:0 sc1
  s_add_u32 s47, s45, 24576
  buffer_load_dwordx4 v[68:71], v1, s[8:11], s47 offen offset:0 sc1
  s_waitcnt vmcnt(13)
  v_mfma_f32_32x32x16_bf16 v[192:207], a[16:19], v[176:179], v[192:207]
  v_mfma_f32_32x32x16_bf16 v[208:223], a[20:23], v[176:179], v[208:223]
  s_waitcnt vmcnt(12)
  v_mfma_f32_32x32x16_bf16 v[224:239], a[16:19], v[180:183], v[224:239]
  v_mfma_f32_32x32x16_bf16 v[240:255], a[20:23], v[180:183], v[240:255]
  buffer_load_dwordx4 v[72:75], v1, s[8:11], s46 offen offset:1024 sc1
  buffer_load_dwordx4 v[76:79], v1, s[8:11], s47 offen offset:1024 sc1
  s_waitcnt vmcnt(13)
  v_mfma_f32_32x32x16_bf16 v[192:207], a[24:27], v[184:187], v[192:207]
  v_mfma_f32_32x32x16_bf16 v[208:223], a[28:31], v[184:187], v[208:223]
  s_waitcnt vmcnt(12)
  v_mfma_f32_32x32x16_bf16 v[224:239], a[24:27], v[188:191], v[224:239]
  v_mfma_f32_32x32x16_bf16 v[240:255], a[28:31], v[188:191], v[240:255]
  buffer_load_dwordx4 v[80:83], v1, s[8:11], s46 offen offset:2048 sc1
  buffer_load_dwordx4 v[84:87], v1, s[8:11], s47 offen offset:2048 sc1
  s_waitcnt vmcnt(13)
  v_mfma_f32_32x32x16_bf16 v[192:207], a[32:35], v[32:35], v[192:207]
  v_mfma_f32_32x32x16_bf16 v[208:223], a[36:39], v[32:35], v[208:223]
  s_waitcnt vmcnt(12)
  v_mfma_f32_32x32x16_bf16 v[224:239], a[32:35], v[36:39], v[224:239]
  v_mfma_f32_32x32x16_bf16 v[240:255], a[36:39], v[36:39], v[240:255]
  buffer_load_dwordx4 v[88:91], v1, s[8:11], s46 offen offset:3072 sc1
  buffer_load_dwordx4 v[92:95], v1, s[8:11], s47 offen offset:3072 sc1
  s_waitcnt vmcnt(13)
  v_mfma_f32_32x32x16_bf16 v[192:207], a[40:43], v[40:43], v[192:207]
  v_mfma_f32_32x32x16_bf16 v[208:223], a[44:47], v[40:43], v[208:223]
  s_waitcnt vmcnt(12)
  v_mfma_f32_32x32x16_bf16 v[224:239], a[40:43], v[44:47], v[224:239]
  v_mfma_f32_32x32x16_bf16 v[240:255], a[44:47], v[44:47], v[240:255]
  s_waitcnt vmcnt(11)
  v_mfma_f32_32x32x16_bf16 v[192:207], a[48:51], v[48:51], v[192:207]
  v_mfma_f32_32x32x16_bf16 v[208:223], a[52:55], v[48:51], v[208:223]
  s_waitcnt vmcnt(10)
  v_mfma_f32_32x32x16_bf16 v[224:239], a[48:51], v[52:55], v[224:239]
  v_mfma_f32_32x32x16_bf16 v[240:255], a[52:55], v[52:55], v[240:255]
  s_mul_i32 s96, s77, 89088
  s_add_u32 s96, s96, 65536
  s_mul_i32 s97, s3, 22528
  s_add_u32 s96, s96, s97
  s_mul_i32 s97, s3, 22880
  s_add_u32 s97, s97, 53248
  s_add_u32 m0, s97, 0
  s_nop 0
  buffer_load_dwordx4 v1, s[48:51], s96 offen offset:0 sc1 lds
  s_add_u32 m0, s97, 16
  s_nop 0
  buffer_load_dwordx4 v1, s[48:51], s96 offen offset:1024 sc1 lds
  s_add_u32 m0, s97, 32
  s_nop 0
  buffer_load_dwordx4 v1, s[48:51], s96 offen offset:2048 sc1 lds
  s_waitcnt vmcnt(12)
  v_mfma_f32_32x32x16_bf16 v[192:207], a[56:59], v[56:59], v[192:207]
  v_mfma_f32_32x32x16_bf16 v[208:223], a[60:63], v[56:59], v[208:223]
  s_waitcnt vmcnt(11)
  v_mfma_f32_32x32x16_bf16 v[224:239], a[56:59], v[60:63], v[224:239]
  v_mfma_f32_32x32x16_bf16 v[240:255], a[60:63], v[60:63], v[240:255]
  s_add_u32 m0, s97, 48
  s_nop 0
  buffer_load_dwordx4 v1, s[48:51], s96 offen offset:3072 sc1 lds
  s_add_u32 s96, s96, 4096
  s_add_u32 m0, s97, 4160
  s_nop 0
  buffer_load_dwordx4 v1, s[48:51], s96 offen offset:0 sc1 lds
  s_add_u32 m0, s97, 4176
  s_nop 0
  buffer_load_dwordx4 v1, s[48:51], s96 offen offset:1024 sc1 lds
  s_add_u32 m0, s97, 4192
  s_nop 0
  buffer_load_dwordx4 v1, s[48:51], s96 offen offset:2048 sc1 lds
  s_waitcnt vmcnt(14)
  v_mfma_f32_32x32x16_bf16 v[192:207], a[64:67], v[64:67], v[192:207]
  v_mfma_f32_32x32x16_bf16 v[208:223], a[68:71], v[64:67], v[208:223]
  s_waitcnt vmcnt(13)
  v_mfma_f32_32x32x16_bf16 v[224:239], a[64:67], v[68:71], v[224:239]
  v_mfma_f32_32x32x16_bf16 v[240:255], a[68:71], v[68:71], v[240:255]
  s_add_u32 m0, s97, 4208
  s_nop 0
  buffer_load_dwordx4 v1, s[48:51], s96 offen offset:3072 sc1 lds
  s_add_u32 s96, s96, 4096
  s_add_u32 m0, s97, 8320
  s_nop 0
  buffer_load_dwordx4 v1, s[48:51], s96 offen offset:0 sc1 lds
  s_add_u32 m0, s97, 8336
  s_nop 0
  buffer_load_dwordx4 v1, s[48:51], s96 offen offset:1024 sc1 lds
  s_add_u32 m0, s97, 8352
  s_nop 0
  buffer_load_dwordx4 v1, s[48:51], s96 offen offset:2048 sc1 lds
  s_waitcnt vmcnt(16)
  v_mfma_f32_32x32x16_bf16 v[192:207], a[72:75], v[72:75], v[192:207]
  v_mfma_f32_32x32x16_bf16 v[208:223], a[76:79], v[72:75], v[208:223]
  s_waitcnt vmcnt(15)
  v_mfma_f32_32x32x16_bf16 v[224:239], a[72:75], v[76:79], v[224:239]
  v_mfma_f32_32x32x16_bf16 v[240:255], a[76:79], v[76:79], v[240:255]
  s_add_u32 m0, s97, 8368
  s_nop 0
  buffer_load_dwordx4 v1, s[48:51], s96 offen offset:3072 sc1 lds
  s_add_u32 s96, s96, 4096
  s_add_u32 m0, s97, 12480
  s_nop 0
  buffer_load_dwordx4 v1, s[48:51], s96 offen offset:0 sc1 lds
  s_add_u32 m0, s97, 12496
  s_nop 0
  buffer_load_dwordx4 v1, s[48:51], s96 offen offset:1024 sc1 lds
  s_add_u32 m0, s97, 12512
  s_nop 0
  buffer_load_dwordx4 v1, s[48:51], s96 offen offset:2048 sc1 lds
  s_waitcnt vmcnt(18)
  v_mfma_f32_32x32x16_bf16 v[192:207], a[80:83], v[80:83], v[192:207]
  v_mfma_f32_32x32x16_bf16 v[208:223], a[84:87], v[80:83], v[208:223]
  s_waitcnt vmcnt(17)
  v_mfma_f32_32x32x16_bf16 v[224:239], a[80:83], v[84:87], v[224:239]
  v_mfma_f32_32x32x16_bf16 v[240:255], a[84:87], v[84:87], v[240:255]
  s_add_u32 m0, s97, 12528
  s_nop 0
  buffer_load_dwordx4 v1, s[48:51], s96 offen offset:3072 sc1 lds
  s_add_u32 s96, s96, 4096
  s_add_u32 m0, s97, 16640
  s_nop 0
  buffer_load_dwordx4 v1, s[48:51], s96 offen offset:0 sc1 lds
  s_add_u32 m0, s97, 16656
  s_nop 0
  buffer_load_dwordx4 v1, s[48:51], s96 offen offset:1024 sc1 lds
  s_add_u32 m0, s97, 16672
  s_nop 0
  buffer_load_dwordx4 v1, s[48:51], s96 offen offset:2048 sc1 lds
  s_waitcnt vmcnt(20)
  v_mfma_f32_32x32x16_bf16 v[192:207], a[88:91], v[88:91], v[192:207]
  v_mfma_f32_32x32x16_bf16 v[208:223], a[92:95], v[88:91], v[208:223]
  s_waitcnt vmcnt(19)
  v_mfma_f32_32x32x16_bf16 v[224:239], a[88:91], v[92:95], v[224:239]
  v_mfma_f32_32x32x16_bf16 v[240:255], a[92:95], v[92:95], v[240:255]
  s_add_u32 m0, s97, 16688
  s_nop 0
  buffer_load_dwordx4 v1, s[48:51], s96 offen offset:3072 sc1 lds
  s_add_u32 s96, s96, 4096
  s_add_u32 m0, s97, 20800
  s_nop 0
  buffer_load_dwordx4 v1, s[48:51], s96 offen offset:0 sc1 lds
  s_add_u32 m0, s97, 20816
  s_nop 0
  buffer_load_dwordx4 v1, s[48:51], s96 offen offset:1024 sc1 lds
  s_xor_b32 s46, s3, 1
  s_mul_i32 s46, s46, 3
  s_add_u32 s46, s46, 0
  s_lshl_b32 s46, s46, 12
  v_add_u32 v20, s46, v1
  ds_write_b128 v20, v[208:211] offset:0
  ds_write_b128 v20, v[212:215] offset:1024
  ds_write_b128 v20, v[216:219] offset:2048
  ds_write_b128 v20, v[220:223] offset:3072
  s_xor_b32 s46, s3, 2
  s_mul_i32 s46, s46, 3
  s_add_u32 s46, s46, 1
  s_lshl_b32 s46, s46, 12
  v_add_u32 v20, s46, v1
  ds_write_b128 v20, v[224:227] offset:0
  ds_write_b128 v20, v[228:231] offset:1024
  ds_write_b128 v20, v[232:235] offset:2048
  ds_write_b128 v20, v[236:239] offset:3072
  s_xor_b32 s46, s3, 3
  s_mul_i32 s46, s46, 3
  s_add_u32 s46, s46, 2
  s_lshl_b32 s46, s46, 12
  v_add_u32 v20, s46, v1
  ds_write_b128 v20, v[240:243] offset:0
  ds_write_b128 v20, v[244:247] offset:1024
  ds_write_b128 v20, v[248:251] offset:2048
  ds_write_b128 v20, v[252:255] offset:3072
  v_lshlrev_b32 v32, 16, v10
  v_and_b32 v33, 0xffff0000, v10
  v_lshlrev_b32 v34, 16, v11
  v_and_b32 v35, 0xffff0000, v11
  v_lshlrev_b32 v36, 16, v12
  v_and_b32 v37, 0xffff0000, v12
  v_lshlrev_b32 v38, 16, v13
  v_and_b32 v39, 0xffff0000, v13
  v_lshlrev_b32 v40, 16, v14
  v_and_b32 v41, 0xffff0000, v14
  v_lshlrev_b32 v42, 16, v15
  v_and_b32 v43, 0xffff0000, v15
  v_lshlrev_b32 v44, 16, v16
  v_and_b32 v45, 0xffff0000, v16
  v_lshlrev_b32 v46, 16, v17
  v_and_b32 v47, 0xffff0000, v17
  s_waitcnt lgkmcnt(0)
  s_barrier
  s_mul_i32 s46, s3, 12288
  v_add_u32 v20, s46, v1
  ds_read_b128 v[64:67], v20 offset:0
  ds_read_b128 v[68:71], v20 offset:1024
  ds_read_b128 v[72:75], v20 offset:2048
  ds_read_b128 v[76:79], v20 offset:3072
  ds_read_b128 v[80:83], v20 offset:4096
  ds_read_b128 v[84:87], v20 offset:5120
  ds_read_b128 v[88:91], v20 offset:6144
  ds_read_b128 v[92:95], v20 offset:7168
  ds_read_b128 v[96:99], v20 offset:8192
  ds_read_b128 v[100:103], v20 offset:9216
  ds_read_b128 v[104:107], v20 offset:10240
  ds_read_b128 v[108:111], v20 offset:11264
  v_mov_b32 v21, 0x3f317218
  s_waitcnt lgkmcnt(11)
  v_pk_add_f32 v[192:193], v[192:193], v[64:65]
  v_pk_add_f32 v[194:195], v[194:195], v[66:67]
  s_waitcnt lgkmcnt(10)
  v_pk_add_f32 v[196:197], v[196:197], v[68:69]
  v_pk_add_f32 v[198:199], v[198:199], v[70:71]
  s_waitcnt lgkmcnt(9)
  v_pk_add_f32 v[200:201], v[200:201], v[72:73]
  v_pk_add_f32 v[202:203], v[202:203], v[74:75]
  s_waitcnt lgkmcnt(8)
  v_pk_add_f32 v[204:205], v[204:205], v[76:77]
  v_pk_add_f32 v[206:207], v[206:207], v[78:79]
  s_waitcnt lgkmcnt(7)
  v_pk_add_f32 v[192:193], v[192:193], v[80:81]
  v_pk_add_f32 v[194:195], v[194:195], v[82:83]
  s_waitcnt lgkmcnt(6)
  v_pk_add_f32 v[196:197], v[196:197], v[84:85]
  v_pk_add_f32 v[198:199], v[198:199], v[86:87]
  s_waitcnt lgkmcnt(5)
  v_pk_add_f32 v[200:201], v[200:201], v[88:89]
  v_pk_add_f32 v[202:203], v[202:203], v[90:91]
  s_waitcnt lgkmcnt(4)
  v_pk_add_f32 v[204:205], v[204:205], v[92:93]
  v_pk_add_f32 v[206:207], v[206:207], v[94:95]
  s_waitcnt lgkmcnt(3)
  v_pk_add_f32 v[192:193], v[192:193], v[96:97]
  v_pk_add_f32 v[194:195], v[194:195], v[98:99]
  s_waitcnt lgkmcnt(2)
  v_pk_add_f32 v[196:197], v[196:197], v[100:101]
  v_pk_add_f32 v[198:199], v[198:199], v[102:103]
  s_waitcnt lgkmcnt(1)
  v_pk_add_f32 v[200:201], v[200:201], v[104:105]
  v_pk_add_f32 v[202:203], v[202:203], v[106:107]
  s_waitcnt lgkmcnt(0)
  v_pk_add_f32 v[204:205], v[204:205], v[108:109]
  v_pk_add_f32 v[206:207], v[206:207], v[110:111]
  v_pk_fma_f32 v[192:193], v[192:193], v[20:21], v[32:33] op_sel:[0,1,0] op_sel_hi:[1,1,1]
  v_pk_fma_f32 v[194:195], v[194:195], v[20:21], v[34:35] op_sel:[0,1,0] op_sel_hi:[1,1,1]
  v_pk_fma_f32 v[196:197], v[196:197], v[20:21], v[36:37] op_sel:[0,1,0] op_sel_hi:[1,1,1]
  v_pk_fma_f32 v[198:199], v[198:199], v[20:21], v[38:39] op_sel:[0,1,0] op_sel_hi:[1,1,1]
  v_pk_fma_f32 v[200:201], v[200:201], v[20:21], v[40:41] op_sel:[0,1,0] op_sel_hi:[1,1,1]
  v_pk_fma_f32 v[202:203], v[202:203], v[20:21], v[42:43] op_sel:[0,1,0] op_sel_hi:[1,1,1]
  v_pk_fma_f32 v[204:205], v[204:205], v[20:21], v[44:45] op_sel:[0,1,0] op_sel_hi:[1,1,1]
  v_pk_fma_f32 v[206:207], v[206:207], v[20:21], v[46:47] op_sel:[0,1,0] op_sel_hi:[1,1,1]
  v_cvt_pk_bf16_f32 v48, v192, v193
  v_cvt_pk_bf16_f32 v49, v194, v195
  v_cvt_pk_bf16_f32 v50, v196, v197
  v_cvt_pk_bf16_f32 v51, v198, v199
  v_cvt_pk_bf16_f32 v52, v200, v201
  v_cvt_pk_bf16_f32 v53, v202, v203
  v_cvt_pk_bf16_f32 v54, v204, v205
  v_cvt_pk_bf16_f32 v55, v206, v207
  s_cmp_eq_u32 s6, 1
  s_cbranch_scc1 L_fin_72
  s_add_u32 s40, s40, 1835008
  buffer_store_dwordx4 v[48:51], v1, s[8:11], s40 offen offset:0 sc1
  buffer_store_dwordx4 v[52:55], v1, s[8:11], s40 offen offset:1024 sc1
  s_mov_b32 s47, 0x3f803f80
  v_mov_b32 v22, 0
  v_mov_b32 v23, 0
  v_mov_b32 v24, 0
  v_mov_b32 v25, 0
  v_dot2_f32_bf16 v22, v48, s47, v22
  v_dot2_f32_bf16 v23, v48, v48, v23
  v_dot2_f32_bf16 v24, v49, s47, v24
  v_dot2_f32_bf16 v25, v49, v49, v25
  v_dot2_f32_bf16 v22, v50, s47, v22
  v_dot2_f32_bf16 v23, v50, v50, v23
  v_dot2_f32_bf16 v24, v51, s47, v24
  v_dot2_f32_bf16 v25, v51, v51, v25
  v_dot2_f32_bf16 v22, v52, s47, v22
  v_dot2_f32_bf16 v23, v52, v52, v23
  v_dot2_f32_bf16 v24, v53, s47, v24
  v_dot2_f32_bf16 v25, v53, v53, v25
  v_dot2_f32_bf16 v22, v54, s47, v22
  v_dot2_f32_bf16 v23, v54, v54, v23
  v_dot2_f32_bf16 v24, v55, s47, v24
  v_dot2_f32_bf16 v25, v55, v55, v25
  s_nop 1
  v_add_f32 v22, v22, v24
  v_add_f32 v23, v23, v25
  v_mov_b32 v24, v22
  s_nop 1
  v_permlane32_swap_b32 v22, v24
  v_add_f32 v22, v22, v24
  v_mov_b32 v24, v23
  s_nop 1
  v_permlane32_swap_b32 v23, v24
  v_add_f32 v23, v23, v24
  s_add_u32 s39, s39, 1
  s_mul_i32 s46, s39, 229376
  s_mul_i32 s47, s36, 14
  s_add_u32 s47, s47, s37
  s_lshl_b32 s47, s47, 8
  s_add_u32 s46, s46, s47
  s_add_u32 s46, s46, 5218304
  v_lshlrev_b32 v24, 3, v2
  s_mov_b64 exec, s[64:65]
  buffer_store_dwordx2 v[22:23], v24, s[8:11], s46 offen offset:0 sc1
  s_mov_b64 exec, -1
  s_lshr_b32 s41, s80, 1
  s_lshl_b32 s41, s41, 7
  s_add_u32 s41, s41, s84
  s_and_b32 s42, s80, 1
  s_mul_i32 s42, s42, 7
  s_add_u32 s42, s42, s81
  s_lshl_b32 s42, s42, 2
  s_add_u32 s41, s41, s42
  s_add_u32 s41, s41, 16384
  s_waitcnt vmcnt(0) lgkmcnt(0)
  s_barrier
  s_cmp_lg_u32 s3, 0
  s_cbranch_scc1 L_sig_74
  v_mov_b32 v4, s41
  s_mov_b64 exec, 1
  buffer_store_dword v3, v4, s[12:15], 0 offen sc1
  buffer_store_dword v3, v4, s[92:95], 0 offen
  s_mov_b64 exec, -1
L_sig_74:
  s_branch L_ks_sig_73
L_fin_72:
  v_and_b32 v22, 31, v2
  v_mul_u32_u24 v22, 896, v22
  v_lshrrev_b32 v23, 5, v2
  v_lshl_add_u32 v22, v23, 4, v22
  s_mul_i32 s46, s36, 28672
  s_lshl_b32 s47, s37, 6
  s_add_u32 s46, s46, s47
  buffer_store_dwordx4 v[48:51], v22, s[20:23], s46 offen offset:0
  buffer_store_dwordx4 v[52:55], v22, s[20:23], s46 offen offset:32
L_ks_sig_73:
  s_branch L_next
L_skip:
  s_cmp_lg_u32 s6, 0
  s_cbranch_scc1 L_next
  s_lshl_b32 s34, s77, 7
  s_add_u32 s34, s34, 0
  s_cmp_lg_u32 s3, 0
  s_cbranch_scc1 L_wd_75
  s_cmp_lg_u32 s60, 0
  s_cbranch_scc1 L_wd_75
  v_lshlrev_b32 v4, 2, v2
  v_add_u32 v4, s34, v4
  s_mov_b32 exec_lo, 0x0000ffff
  s_mov_b32 exec_hi, 0x00000000
  s_mov_b32 s58, 0
L_poll_76:
  buffer_load_dword v7, v4, s[8:11], 0 offen sc1
  s_waitcnt vmcnt(0)
  v_cmp_eq_u32 vcc, 1, v7
  s_add_u32 s58, s58, 1
  s_cmp_eq_u64 vcc, exec
  s_cbranch_scc1 L_wd_75_d
  s_cmp_lt_u32 s58, 60000
  s_cbranch_scc1 L_poll_76
  s_or_b32 s60, s60, 1
L_wd_75_d:
  s_mov_b64 exec, -1
L_wd_75:
  s_waitcnt vmcnt(0) lgkmcnt(0)
  s_barrier
  s_mul_i32 s96, s77, 89088
  s_add_u32 s96, s96, 65536
  s_mul_i32 s97, s3, 22528
  s_add_u32 s96, s96, s97
  s_mul_i32 s97, s3, 22880
  s_add_u32 s97, s97, 53248
  s_add_u32 m0, s97, 0
  s_nop 0
  buffer_load_dwordx4 v1, s[8:11], s96 offen offset:0 sc1 lds
  s_add_u32 m0, s97, 16
  s_nop 0
  buffer_load_dwordx4 v1, s[8:11], s96 offen offset:1024 sc1 lds
  s_add_u32 m0, s97, 32
  s_nop 0
  buffer_load_dwordx4 v1, s[8:11], s96 offen offset:2048 sc1 lds
  s_add_u32 m0, s97, 48
  s_nop 0
  buffer_load_dwordx4 v1, s[8:11], s96 offen offset:3072 sc1 lds
  s_add_u32 s96, s96, 4096
  s_add_u32 m0, s97, 4160
  s_nop 0
  buffer_load_dwordx4 v1, s[8:11], s96 offen offset:0 sc1 lds
  s_add_u32 m0, s97, 4176
  s_nop 0
  buffer_load_dwordx4 v1, s[8:11], s96 offen offset:1024 sc1 lds
  s_add_u32 m0, s97, 4192
  s_nop 0
  buffer_load_dwordx4 v1, s[8:11], s96 offen offset:2048 sc1 lds
  s_add_u32 m0, s97, 4208
  s_nop 0
  buffer_load_dwordx4 v1, s[8:11], s96 offen offset:3072 sc1 lds
  s_add_u32 s96, s96, 4096
  s_add_u32 m0, s97, 8320
  s_nop 0
  buffer_load_dwordx4 v1, s[8:11], s96 offen offset:0 sc1 lds
  s_add_u32 m0, s97, 8336
  s_nop 0
  buffer_load_dwordx4 v1, s[8:11], s96 offen offset:1024 sc1 lds
  s_add_u32 m0, s97, 8352
  s_nop 0
  buffer_load_dwordx4 v1, s[8:11], s96 offen offset:2048 sc1 lds
  s_add_u32 m0, s97, 8368
  s_nop 0
  buffer_load_dwordx4 v1, s[8:11], s96 offen offset:3072 sc1 lds
  s_add_u32 s96, s96, 4096
  s_add_u32 m0, s97, 12480
  s_nop 0
  buffer_load_dwordx4 v1, s[8:11], s96 offen offset:0 sc1 lds
  s_add_u32 m0, s97, 12496
  s_nop 0
  buffer_load_dwordx4 v1, s[8:11], s96 offen offset:1024 sc1 lds
  s_add_u32 m0, s97, 12512
  s_nop 0
  buffer_load_dwordx4 v1, s[8:11], s96 offen offset:2048 sc1 lds
  s_add_u32 m0, s97, 12528
  s_nop 0
  buffer_load_dwordx4 v1, s[8:11], s96 offen offset:3072 sc1 lds
  s_add_u32 s96, s96, 4096
  s_add_u32 m0, s97, 16640
  s_nop 0
  buffer_load_dwordx4 v1, s[8:11], s96 offen offset:0 sc1 lds
  s_add_u32 m0, s97, 16656
  s_nop 0
  buffer_load_dwordx4 v1, s[8:11], s96 offen offset:1024 sc1 lds
  s_add_u32 m0, s97, 16672
  s_nop 0
  buffer_load_dwordx4 v1, s[8:11], s96 offen offset:2048 sc1 lds
  s_add_u32 m0, s97, 16688
  s_nop 0
  buffer_load_dwordx4 v1, s[8:11], s96 offen offset:3072 sc1 lds
  s_add_u32 s96, s96, 4096
  s_add_u32 m0, s97, 20800
  s_nop 0
  buffer_load_dwordx4 v1, s[8:11], s96 offen offset:0 sc1 lds
  s_add_u32 m0, s97, 20816
  s_nop 0
  buffer_load_dwordx4 v1, s[8:11], s96 offen offset:1024 sc1 lds
L_next:
  s_add_u32 s6, s6, 1
  s_cmp_lt_u32 s6, 2
  s_cbranch_scc1 L_layer
  s_cmp_eq_u32 s60, 0
  s_cbranch_scc1 L_end
  v_mov_b32 v4, 4
  s_mov_b64 exec, 1
  buffer_store_dword v3, v4, s[16:19], 0 offen
L_end:
  s_endpgm
.section .rodata,"a"
.p2align 6
.amdhsa_kernel interleave_layers__softmax_full_mha__dense_activation_mish__prompt_kernel
  .amdhsa_next_free_vgpr 512
  .amdhsa_next_free_sgpr 102
  .amdhsa_accum_offset 256
  .amdhsa_group_segment_fixed_size 0
  .amdhsa_kernarg_size 80
  .amdhsa_user_sgpr_count 2
  .amdhsa_user_sgpr_kernarg_segment_ptr 1
  .amdhsa_system_sgpr_workgroup_id_x 1
.end_amdhsa_kernel
```
